```python
import torch

def _softmax(x, axis=-1):
    return torch.softmax(x, dim=axis)
def _gelu(x):
    return torch.nn.functional.gelu(x, approximate="tanh")
def _silu(x):
    return torch.nn.functional.silu(x)
def _sigmoid(x):
    return torch.sigmoid(x)
def _layernorm(x, axis=-1, eps=1e-5):
    m = x.mean(dim=axis, keepdim=True)
    v = x.var(dim=axis, keepdim=True, unbiased=False)
    return (x - m) / torch.sqrt(v + eps)
def _scatter_add(tgt, idx, src, axis=0):
    return tgt.clone().index_add_(axis, idx, src)
def _segment_sum(src, seg, n):
    out = torch.zeros((n,) + src.shape[1:], dtype=src.dtype)
    return out.index_add_(0, seg, src)
def _pad(x, pw):
    flat = tuple(v for pair in reversed(pw) for v in pair)
    return torch.nn.functional.pad(x, flat)

kernel_name = 'standalone__gqa_softmax__decode'

def setup_inputs():

    _w = (lambda a: (lambda t: t.to(torch.bfloat16) if t.is_floating_point() else t)(torch.as_tensor(a)))
    B, Hq, Hkv, Sq, Sk, D = 2, 32, 16, 1, 8192, 128
    return {
        "q": _w((lambda *s: torch.randn(*s, dtype=torch.bfloat16) * 0.8)(B, Hq, Sq, D)),
        "k": _w((lambda *s: torch.randn(*s, dtype=torch.bfloat16) * 0.8)(B, Hkv, Sk, D)),
        "v": _w((lambda *s: torch.randn(*s, dtype=torch.bfloat16) * 0.05)(B, Hkv, Sk, D)),
    }

def reference(q, k, v):
    B, Hq, Sq, D = q.shape
    Hkv = k.shape[1]
    rep = Hq // Hkv
    k = (lambda x, n, axis: torch.repeat_interleave(x, n, dim=axis))(k, rep, axis=1)
    v = (lambda x, n, axis: torch.repeat_interleave(x, n, dim=axis))(v, rep, axis=1)
    scale = D ** -0.5
    scores = torch.einsum("bhqd,bhkd->bhqk", q, k) * scale
    p = _softmax(scores, axis=-1)
    return torch.einsum("bhqk,bhkd->bhqd", p, v)
```

```asm
; @launch grid=(256,1,1) block=(320,1,1) lds=16384
.amdgcn_target "amdgcn-amd-amdhsa--gfx950"
.text
.globl standalone__gqa_softmax__decode_kernel
.p2align 8
.type standalone__gqa_softmax__decode_kernel,@function
standalone__gqa_softmax__decode_kernel:
    s_cmp_ge_u32 s2, 256
    s_cbranch_scc1 L_end
    s_load_dwordx4 s[4:7], s[0:1], 0
    s_load_dwordx4 s[8:11], s[0:1], 16
    s_load_dwordx4 s[12:15], s[0:1], 32
    s_getpc_b64 s[62:63]
L_pc:
    v_mul_u32_u24 v20, 40, v0
    v_mov_b32 v21, s63
    v_add_co_u32 v20, vcc, s62, v20
    v_lshrrev_b32 v3, 6, v0
    v_and_b32 v0, 63, v0
    v_addc_co_u32 v21, vcc, 0, v21, vcc
    global_load_dword v24, v[20:21], off
    v_readfirstlane_b32 s40, v3
    v_mov_b32 v39, 0
    v_and_b32 v32, 12, v0
    ds_write_b32 v32, v39 offset:5696
    v_bfe_u32 v1, v0, 2, 2
    v_lshlrev_b32 v1, 8, v1
    v_lshrrev_b32 v3, 4, v0
    v_lshlrev_b32 v3, 6, v3
    v_and_b32 v32, 3, v0
    v_lshl_add_u32 v3, v32, 4, v3
    v_add_u32 v1, v1, v3
    v_bfe_u32 v32, v0, 3, 1
    v_lshl_add_u32 v3, v32, 8, v3
    s_and_b32 s41, s2, 31
    s_lshr_b32 s52, s41, 3
    s_lshl_b32 s52, s52, 2
    s_lshr_b32 s52, 0x1670, s52
    s_and_b32 s52, s52, 7
    s_xor_b32 s41, s41, s52
    s_lshr_b32 s42, s2, 5
    s_lshl_b32 s43, s41, 21
    s_lshl_b32 s52, s40, 12
    s_add_u32 s43, s43, s52
    s_lshl_b32 s52, s42, 18
    s_add_u32 s43, s43, s52
    s_mov_b32 s46, s43
    s_lshl_b32 s44, s41, 9
    s_mov_b32 s22, 0x4000000
    s_mov_b32 s23, 0x20000
    s_mov_b32 s18, 16384
    s_mov_b32 s19, 0x20000
    s_cmp_eq_u32 s40, 4
    s_waitcnt lgkmcnt(0)
    s_mov_b32 s20, s6
    s_mov_b32 s21, s7
    s_cbranch_scc0 L_stream
    s_barrier
    s_branch L_helper
L_stream:
    buffer_load_dwordx4 v[96:99], v1, s[20:23], s46 offen offset:0 nt
    s_mov_b32 s16, s4
    s_mov_b32 s17, s5
    buffer_load_dwordx4 v[4:7], v3, s[16:19], s44 offen
    s_mov_b32 s24, s8
    buffer_load_dwordx4 v[100:103], v1, s[20:23], s46 offen offset:1024 nt
    s_mov_b32 s25, s9
    buffer_load_dwordx4 v[104:107], v1, s[20:23], s46 offen offset:2048 nt
    s_mov_b32 s36, s14
    buffer_load_dwordx4 v[108:111], v1, s[20:23], s46 offen offset:3072 nt
    s_mov_b32 s37, s15
    s_xor_b32 s46, s43, 16384
    buffer_load_dwordx4 v[112:115], v1, s[20:23], s46 offen offset:0 nt
    s_mov_b32 s28, s10
    s_barrier
    s_mov_b32 s29, s11
    s_mov_b32 vcc_lo, 0xf0f0f0f0
    s_mov_b32 vcc_hi, 0xf0f0f0f0
    s_waitcnt vmcnt(4)
    v_cndmask_b32 v8, 0, v4, vcc
    v_cndmask_b32 v9, 0, v5, vcc
    v_cndmask_b32 v10, 0, v6, vcc
    v_cndmask_b32 v11, 0, v7, vcc
    s_not_b64 vcc, vcc
    v_cndmask_b32 v4, 0, v4, vcc
    v_cndmask_b32 v5, 0, v5, vcc
    v_cndmask_b32 v6, 0, v6, vcc
    v_cndmask_b32 v7, 0, v7, vcc
    s_nop 0
    s_waitcnt vmcnt(4)
    buffer_load_dwordx4 v[116:119], v1, s[20:23], s46 offen offset:1024 nt
    v_mfma_f32_16x16x32_bf16 v[20:23], v[96:99], v[4:7], 0
    s_waitcnt vmcnt(4)
    buffer_load_dwordx4 v[120:123], v1, s[20:23], s46 offen offset:2048 nt
    v_mfma_f32_16x16x32_bf16 v[20:23], v[100:103], v[8:11], v[20:23]
    s_waitcnt vmcnt(4)
    buffer_load_dwordx4 v[124:127], v1, s[20:23], s46 offen offset:3072 nt
    v_mfma_f32_16x16x32_bf16 v[24:27], v[104:107], v[4:7], 0
    s_waitcnt vmcnt(4)
    s_xor_b32 s46, s43, 32768
    buffer_load_dwordx4 v[96:99], v1, s[20:23], s46 offen offset:0 nt
    v_mfma_f32_16x16x32_bf16 v[24:27], v[108:111], v[8:11], v[24:27]
    s_nop 1
    v_mov_b32_dpp v64, v20 quad_perm:[0,0,0,0] row_mask:0xf bank_mask:0xf
    v_add_f32_dpp v64, v21, v64 quad_perm:[1,1,1,1] row_mask:0xf bank_mask:0xf
    v_add_f32_dpp v64, v22, v64 quad_perm:[2,2,2,2] row_mask:0xf bank_mask:0xf
    v_add_f32_dpp v64, v23, v64 quad_perm:[3,3,3,3] row_mask:0xf bank_mask:0xf
    s_waitcnt vmcnt(4)
    buffer_load_dwordx4 v[100:103], v1, s[20:23], s46 offen offset:1024 nt
    v_mfma_f32_16x16x32_bf16 v[20:23], v[112:115], v[4:7], 0
    s_waitcnt vmcnt(4)
    buffer_load_dwordx4 v[104:107], v1, s[20:23], s46 offen offset:2048 nt
    v_mfma_f32_16x16x32_bf16 v[20:23], v[116:119], v[8:11], v[20:23]
    s_nop 1
    v_mov_b32_dpp v65, v24 quad_perm:[0,0,0,0] row_mask:0xf bank_mask:0xf
    v_add_f32_dpp v65, v25, v65 quad_perm:[1,1,1,1] row_mask:0xf bank_mask:0xf
    v_add_f32_dpp v65, v26, v65 quad_perm:[2,2,2,2] row_mask:0xf bank_mask:0xf
    v_add_f32_dpp v65, v27, v65 quad_perm:[3,3,3,3] row_mask:0xf bank_mask:0xf
    v_max_f32 v28, v64, v65
    s_waitcnt vmcnt(4)
    buffer_load_dwordx4 v[108:111], v1, s[20:23], s46 offen offset:3072 nt
    v_mfma_f32_16x16x32_bf16 v[24:27], v[120:123], v[4:7], 0
    s_waitcnt vmcnt(4)
    s_xor_b32 s46, s43, 49152
    buffer_load_dwordx4 v[112:115], v1, s[20:23], s46 offen offset:0 nt
    v_mfma_f32_16x16x32_bf16 v[24:27], v[124:127], v[8:11], v[24:27]
    s_nop 1
    v_mov_b32_dpp v66, v20 quad_perm:[0,0,0,0] row_mask:0xf bank_mask:0xf
    v_add_f32_dpp v66, v21, v66 quad_perm:[1,1,1,1] row_mask:0xf bank_mask:0xf
    v_add_f32_dpp v66, v22, v66 quad_perm:[2,2,2,2] row_mask:0xf bank_mask:0xf
    v_add_f32_dpp v66, v23, v66 quad_perm:[3,3,3,3] row_mask:0xf bank_mask:0xf
    v_max_f32 v28, v28, v66
    v_mov_b32 v60, 0
    v_mov_b32 v61, 1
    v_lshlrev_b32 v2, 4, v0
    s_mov_b32 s38, 1048576
    s_waitcnt vmcnt(4)
    buffer_load_dwordx4 v[116:119], v1, s[20:23], s46 offen offset:1024 nt
    v_mfma_f32_16x16x32_bf16 v[20:23], v[96:99], v[4:7], 0
    s_waitcnt vmcnt(4)
    buffer_load_dwordx4 v[120:123], v1, s[20:23], s46 offen offset:2048 nt
    v_mfma_f32_16x16x32_bf16 v[20:23], v[100:103], v[8:11], v[20:23]
    s_nop 1
    v_mov_b32_dpp v67, v24 quad_perm:[0,0,0,0] row_mask:0xf bank_mask:0xf
    v_add_f32_dpp v67, v25, v67 quad_perm:[1,1,1,1] row_mask:0xf bank_mask:0xf
    v_add_f32_dpp v67, v26, v67 quad_perm:[2,2,2,2] row_mask:0xf bank_mask:0xf
    v_add_f32_dpp v67, v27, v67 quad_perm:[3,3,3,3] row_mask:0xf bank_mask:0xf
    v_max_f32 v28, v28, v67
    s_mov_b32 s39, 0x20000
    s_lshl_b32 s47, s41, 3
    s_add_u32 s47, s47, s42
    s_lshl_b32 s47, s47, 11
    s_waitcnt vmcnt(4)
    buffer_load_dwordx4 v[124:127], v1, s[20:23], s46 offen offset:3072 nt
    v_mfma_f32_16x16x32_bf16 v[24:27], v[104:107], v[4:7], 0
    s_waitcnt vmcnt(4)
    s_xor_b32 s46, s43, 65536
    buffer_load_dwordx4 v[96:99], v1, s[20:23], s46 offen offset:0 nt
    v_mfma_f32_16x16x32_bf16 v[24:27], v[108:111], v[8:11], v[24:27]
    s_nop 1
    v_mov_b32_dpp v68, v20 quad_perm:[0,0,0,0] row_mask:0xf bank_mask:0xf
    v_add_f32_dpp v68, v21, v68 quad_perm:[1,1,1,1] row_mask:0xf bank_mask:0xf
    v_add_f32_dpp v68, v22, v68 quad_perm:[2,2,2,2] row_mask:0xf bank_mask:0xf
    v_add_f32_dpp v68, v23, v68 quad_perm:[3,3,3,3] row_mask:0xf bank_mask:0xf
    v_max_f32 v28, v28, v68
    s_getreg_b32 s49, hwreg(HW_REG_XCC_ID, 0, 4)
    s_or_b32 s49, s49, 0x100
    s_mov_b32 s50, 0x100000
    v_lshlrev_b32 v38, 3, v0
    s_waitcnt vmcnt(4)
    buffer_load_dwordx4 v[100:103], v1, s[20:23], s46 offen offset:1024 nt
    v_mfma_f32_16x16x32_bf16 v[20:23], v[112:115], v[4:7], 0
    s_waitcnt vmcnt(4)
    buffer_load_dwordx4 v[104:107], v1, s[20:23], s46 offen offset:2048 nt
    v_mfma_f32_16x16x32_bf16 v[20:23], v[116:119], v[8:11], v[20:23]
    s_nop 1
    v_mov_b32_dpp v69, v24 quad_perm:[0,0,0,0] row_mask:0xf bank_mask:0xf
    v_add_f32_dpp v69, v25, v69 quad_perm:[1,1,1,1] row_mask:0xf bank_mask:0xf
    v_add_f32_dpp v69, v26, v69 quad_perm:[2,2,2,2] row_mask:0xf bank_mask:0xf
    v_add_f32_dpp v69, v27, v69 quad_perm:[3,3,3,3] row_mask:0xf bank_mask:0xf
    v_max_f32 v28, v28, v69
    v_and_b32 v30, 7, v0
    v_lshrrev_b32 v42, 3, v0
    v_lshlrev_b32 v41, 11, v42
    v_lshl_add_u32 v41, v30, 3, v41
    s_waitcnt vmcnt(4)
    buffer_load_dwordx4 v[108:111], v1, s[20:23], s46 offen offset:3072 nt
    v_mfma_f32_16x16x32_bf16 v[24:27], v[120:123], v[4:7], 0
    s_waitcnt vmcnt(4)
    s_xor_b32 s46, s43, 81920
    buffer_load_dwordx4 v[112:115], v1, s[20:23], s46 offen offset:0 nt
    v_mfma_f32_16x16x32_bf16 v[24:27], v[124:127], v[8:11], v[24:27]
    s_nop 1
    v_mov_b32_dpp v70, v20 quad_perm:[0,0,0,0] row_mask:0xf bank_mask:0xf
    v_add_f32_dpp v70, v21, v70 quad_perm:[1,1,1,1] row_mask:0xf bank_mask:0xf
    v_add_f32_dpp v70, v22, v70 quad_perm:[2,2,2,2] row_mask:0xf bank_mask:0xf
    v_add_f32_dpp v70, v23, v70 quad_perm:[3,3,3,3] row_mask:0xf bank_mask:0xf
    v_max_f32 v28, v28, v70
    v_bfe_u32 v31, v0, 3, 1
    v_lshlrev_b32 v35, 5, v31
    s_mov_b32 s26, 0x4000000
    s_mov_b32 s27, 0x20000
    s_waitcnt vmcnt(4)
    buffer_load_dwordx4 v[116:119], v1, s[20:23], s46 offen offset:1024 nt
    v_mfma_f32_16x16x32_bf16 v[20:23], v[96:99], v[4:7], 0
    s_mov_b64 exec, 1
    ds_add_u32 v39, v61 offset:5700
    s_mov_b64 exec, -1
    s_waitcnt vmcnt(4)
    buffer_load_dwordx4 v[120:123], v1, s[20:23], s46 offen offset:2048 nt
    v_mfma_f32_16x16x32_bf16 v[20:23], v[100:103], v[8:11], v[20:23]
    s_nop 1
    v_mov_b32_dpp v71, v24 quad_perm:[0,0,0,0] row_mask:0xf bank_mask:0xf
    v_add_f32_dpp v71, v25, v71 quad_perm:[1,1,1,1] row_mask:0xf bank_mask:0xf
    v_add_f32_dpp v71, v26, v71 quad_perm:[2,2,2,2] row_mask:0xf bank_mask:0xf
    v_add_f32_dpp v71, v27, v71 quad_perm:[3,3,3,3] row_mask:0xf bank_mask:0xf
    v_max_f32 v28, v28, v71
    s_mov_b32 s30, 16384
    s_mov_b32 s31, 0x20000
    v_mul_u32_u24 v34, 704, v31
    v_lshrrev_b32 v31, 4, v0
    s_waitcnt vmcnt(4)
    buffer_load_dwordx4 v[124:127], v1, s[20:23], s46 offen offset:3072 nt
    v_mfma_f32_16x16x32_bf16 v[24:27], v[104:107], v[4:7], 0
    s_waitcnt vmcnt(4)
    s_xor_b32 s46, s43, 98304
    buffer_load_dwordx4 v[96:99], v1, s[20:23], s46 offen offset:0 nt
    v_mfma_f32_16x16x32_bf16 v[24:27], v[108:111], v[8:11], v[24:27]
    s_nop 1
    v_mov_b32_dpp v72, v20 quad_perm:[0,0,0,0] row_mask:0xf bank_mask:0xf
    v_add_f32_dpp v72, v21, v72 quad_perm:[1,1,1,1] row_mask:0xf bank_mask:0xf
    v_add_f32_dpp v72, v22, v72 quad_perm:[2,2,2,2] row_mask:0xf bank_mask:0xf
    v_add_f32_dpp v72, v23, v72 quad_perm:[3,3,3,3] row_mask:0xf bank_mask:0xf
    v_max_f32 v28, v28, v72
    v_lshlrev_b32 v43, 5, v31
    v_lshl_add_u32 v43, v30, 2, v43
    v_mul_u32_u24 v31, 160, v31
    v_add_u32 v34, v34, v31
    s_waitcnt vmcnt(4)
    buffer_load_dwordx4 v[100:103], v1, s[20:23], s46 offen offset:1024 nt
    v_mfma_f32_16x16x32_bf16 v[20:23], v[112:115], v[4:7], 0
    s_mov_b64 exec, 1
    ds_add_u32 v39, v61 offset:5700
    s_mov_b64 exec, -1
    s_waitcnt vmcnt(4)
    buffer_load_dwordx4 v[104:107], v1, s[20:23], s46 offen offset:2048 nt
    v_mfma_f32_16x16x32_bf16 v[20:23], v[116:119], v[8:11], v[20:23]
    s_nop 1
    v_mov_b32_dpp v73, v24 quad_perm:[0,0,0,0] row_mask:0xf bank_mask:0xf
    v_add_f32_dpp v73, v25, v73 quad_perm:[1,1,1,1] row_mask:0xf bank_mask:0xf
    v_add_f32_dpp v73, v26, v73 quad_perm:[2,2,2,2] row_mask:0xf bank_mask:0xf
    v_add_f32_dpp v73, v27, v73 quad_perm:[3,3,3,3] row_mask:0xf bank_mask:0xf
    v_max_f32 v28, v28, v73
    v_lshl_add_u32 v34, v30, 2, v34
    s_mul_i32 s52, s40, 1408
    v_add_u32 v34, s52, v34
    s_lshl_b32 s52, s40, 3
    s_waitcnt vmcnt(4)
    buffer_load_dwordx4 v[108:111], v1, s[20:23], s46 offen offset:3072 nt
    v_mfma_f32_16x16x32_bf16 v[24:27], v[120:123], v[4:7], 0
    s_waitcnt vmcnt(4)
    s_xor_b32 s46, s43, 114688
    buffer_load_dwordx4 v[112:115], v1, s[20:23], s46 offen offset:0 nt
    v_mfma_f32_16x16x32_bf16 v[24:27], v[124:127], v[8:11], v[24:27]
    s_nop 1
    v_mov_b32_dpp v74, v20 quad_perm:[0,0,0,0] row_mask:0xf bank_mask:0xf
    v_add_f32_dpp v74, v21, v74 quad_perm:[1,1,1,1] row_mask:0xf bank_mask:0xf
    v_add_f32_dpp v74, v22, v74 quad_perm:[2,2,2,2] row_mask:0xf bank_mask:0xf
    v_add_f32_dpp v74, v23, v74 quad_perm:[3,3,3,3] row_mask:0xf bank_mask:0xf
    v_max_f32 v28, v28, v74
    v_add_u32 v35, s52, v35
    s_lshr_b32 s52, s40, 1
    s_and_b32 s53, s40, 1
    s_mul_i32 s51, s52, 704
    s_waitcnt vmcnt(4)
    buffer_load_dwordx4 v[116:119], v1, s[20:23], s46 offen offset:1024 nt
    v_mfma_f32_16x16x32_bf16 v[20:23], v[96:99], v[4:7], 0
    s_mov_b64 exec, 1
    ds_add_u32 v39, v61 offset:5700
    s_mov_b64 exec, -1
    s_waitcnt vmcnt(4)
    buffer_load_dwordx4 v[120:123], v1, s[20:23], s46 offen offset:2048 nt
    v_mfma_f32_16x16x32_bf16 v[20:23], v[100:103], v[8:11], v[20:23]
    s_nop 1
    v_mov_b32_dpp v75, v24 quad_perm:[0,0,0,0] row_mask:0xf bank_mask:0xf
    v_add_f32_dpp v75, v25, v75 quad_perm:[1,1,1,1] row_mask:0xf bank_mask:0xf
    v_add_f32_dpp v75, v26, v75 quad_perm:[2,2,2,2] row_mask:0xf bank_mask:0xf
    v_add_f32_dpp v75, v27, v75 quad_perm:[3,3,3,3] row_mask:0xf bank_mask:0xf
    v_max_f32 v28, v28, v75
    s_mul_i32 s54, s53, 320
    s_add_u32 s51, s51, s54
    v_lshrrev_b32 v36, 5, v0
    v_mul_u32_u24 v36, 160, v36
    s_waitcnt vmcnt(4)
    buffer_load_dwordx4 v[124:127], v1, s[20:23], s46 offen offset:3072 nt
    v_mfma_f32_16x16x32_bf16 v[24:27], v[104:107], v[4:7], 0
    s_waitcnt vmcnt(4)
    s_xor_b32 s46, s43, 131072
    buffer_load_dwordx4 v[96:99], v1, s[20:23], s46 offen offset:0 nt
    v_mfma_f32_16x16x32_bf16 v[24:27], v[108:111], v[8:11], v[24:27]
    s_nop 1
    v_mov_b32_dpp v76, v20 quad_perm:[0,0,0,0] row_mask:0xf bank_mask:0xf
    v_add_f32_dpp v76, v21, v76 quad_perm:[1,1,1,1] row_mask:0xf bank_mask:0xf
    v_add_f32_dpp v76, v22, v76 quad_perm:[2,2,2,2] row_mask:0xf bank_mask:0xf
    v_add_f32_dpp v76, v23, v76 quad_perm:[3,3,3,3] row_mask:0xf bank_mask:0xf
    v_max_f32 v28, v28, v76
    v_and_b32 v33, 31, v0
    v_lshl_add_u32 v36, v33, 2, v36
    v_add_u32 v36, s51, v36
    v_bfe_u32 v31, v0, 3, 2
    s_waitcnt vmcnt(4)
    buffer_load_dwordx4 v[100:103], v1, s[20:23], s46 offen offset:1024 nt
    v_mfma_f32_16x16x32_bf16 v[20:23], v[112:115], v[4:7], 0
    s_mov_b64 exec, 1
    ds_add_u32 v39, v61 offset:5700
    s_mov_b64 exec, -1
    s_waitcnt vmcnt(4)
    buffer_load_dwordx4 v[104:107], v1, s[20:23], s46 offen offset:2048 nt
    v_mfma_f32_16x16x32_bf16 v[20:23], v[116:119], v[8:11], v[20:23]
    s_waitcnt lgkmcnt(0)
    v_cmp_ne_u32 vcc, 0, v60
    ds_read_b32 v60, v39 offset:5704
    s_nop 1
    v_mov_b32_dpp v77, v24 quad_perm:[0,0,0,0] row_mask:0xf bank_mask:0xf
    v_add_f32_dpp v77, v25, v77 quad_perm:[1,1,1,1] row_mask:0xf bank_mask:0xf
    v_add_f32_dpp v77, v26, v77 quad_perm:[2,2,2,2] row_mask:0xf bank_mask:0xf
    v_add_f32_dpp v77, v27, v77 quad_perm:[3,3,3,3] row_mask:0xf bank_mask:0xf
    v_max_f32 v28, v28, v77
    v_mul_u32_u24 v40, 1408, v31
    v_lshl_add_u32 v40, v30, 3, v40
    v_add_u32 v40, s51, v40
    s_lshl_b32 s54, s52, 5
    s_waitcnt vmcnt(4)
    s_cbranch_vccnz L_gt35
    s_waitcnt vmcnt(4)
L_gt35:
    buffer_load_dwordx4 v[108:111], v1, s[20:23], s46 offen offset:3072 nt
    s_cbranch_vccnz L_gt36
    s_waitcnt vmcnt(4)
L_gt36:
    s_xor_b32 s46, s43, 147456
    buffer_load_dwordx4 v[112:115], v1, s[20:23], s46 offen offset:0 nt
    v_mfma_f32_16x16x32_bf16 v[24:27], v[120:123], v[4:7], 0
    s_waitcnt vmcnt(5)
    s_cbranch_vccnz L_gt37
    s_waitcnt vmcnt(4)
L_gt37:
    buffer_load_dwordx4 v[116:119], v1, s[20:23], s46 offen offset:1024 nt
    v_mfma_f32_16x16x32_bf16 v[24:27], v[124:127], v[8:11], v[24:27]
    s_waitcnt lgkmcnt(0)
    v_cmp_ne_u32 vcc, 0, v60
    ds_read_b32 v60, v39 offset:5704
    s_nop 1
    v_mov_b32_dpp v78, v20 quad_perm:[0,0,0,0] row_mask:0xf bank_mask:0xf
    v_add_f32_dpp v78, v21, v78 quad_perm:[1,1,1,1] row_mask:0xf bank_mask:0xf
    v_add_f32_dpp v78, v22, v78 quad_perm:[2,2,2,2] row_mask:0xf bank_mask:0xf
    v_add_f32_dpp v78, v23, v78 quad_perm:[3,3,3,3] row_mask:0xf bank_mask:0xf
    v_max_f32 v28, v28, v78
    v_lshl_add_u32 v42, v42, 2, s54
    s_lshl_b32 s51, s40, 8
    v_lshl_add_u32 v37, v0, 2, s51
    v_add_u32 v41, s51, v41
    s_waitcnt vmcnt(5)
    s_cbranch_vccnz L_gt38
    s_waitcnt vmcnt(4)
L_gt38:
    buffer_load_dwordx4 v[120:123], v1, s[20:23], s46 offen offset:2048 nt
    v_mfma_f32_16x16x32_bf16 v[20:23], v[96:99], v[4:7], 0
    s_mov_b64 exec, 1
    ds_add_u32 v39, v61 offset:5700
    s_mov_b64 exec, -1
    s_waitcnt vmcnt(5)
    s_cbranch_vccnz L_gt39
    s_waitcnt vmcnt(4)
L_gt39:
    buffer_load_dwordx4 v[124:127], v1, s[20:23], s46 offen offset:3072 nt
    v_mfma_f32_16x16x32_bf16 v[20:23], v[100:103], v[8:11], v[20:23]
    s_waitcnt lgkmcnt(0)
    v_cmp_ne_u32 vcc, 0, v60
    ds_read_b32 v60, v39 offset:5704
    s_nop 1
    v_mov_b32_dpp v79, v24 quad_perm:[0,0,0,0] row_mask:0xf bank_mask:0xf
    v_add_f32_dpp v79, v25, v79 quad_perm:[1,1,1,1] row_mask:0xf bank_mask:0xf
    v_add_f32_dpp v79, v26, v79 quad_perm:[2,2,2,2] row_mask:0xf bank_mask:0xf
    v_add_f32_dpp v79, v27, v79 quad_perm:[3,3,3,3] row_mask:0xf bank_mask:0xf
    v_max_f32 v28, v28, v79
    s_lshl_b32 s51, s40, 11
    v_add_u32 v38, s51, v38
    s_lshl_b32 s51, s40, 7
    s_add_u32 s51, s51, s44
    s_waitcnt vmcnt(5)
    s_cbranch_vccnz L_gt40
    s_waitcnt vmcnt(4)
L_gt40:
    s_xor_b32 s46, s43, 163840
    buffer_load_dwordx4 v[96:99], v1, s[20:23], s46 offen offset:0 nt
    v_mfma_f32_16x16x32_bf16 v[24:27], v[104:107], v[4:7], 0
    s_waitcnt vmcnt(5)
    s_cbranch_vccnz L_gt41
    s_waitcnt vmcnt(4)
L_gt41:
    buffer_load_dwordx4 v[100:103], v1, s[20:23], s46 offen offset:1024 nt
    v_mfma_f32_16x16x32_bf16 v[24:27], v[108:111], v[8:11], v[24:27]
    s_waitcnt lgkmcnt(0)
    v_cmp_ne_u32 vcc, 0, v60
    ds_read_b32 v60, v39 offset:5704
    s_nop 1
    v_mov_b32_dpp v80, v20 quad_perm:[0,0,0,0] row_mask:0xf bank_mask:0xf
    v_add_f32_dpp v80, v21, v80 quad_perm:[1,1,1,1] row_mask:0xf bank_mask:0xf
    v_add_f32_dpp v80, v22, v80 quad_perm:[2,2,2,2] row_mask:0xf bank_mask:0xf
    v_add_f32_dpp v80, v23, v80 quad_perm:[3,3,3,3] row_mask:0xf bank_mask:0xf
    v_max_f32 v28, v28, v80
    s_mov_b32 s45, 1040356334
    v_and_b32 v31, 1, v0
    v_lshlrev_b32 v31, 4, v31
    v_mov_b32 v32, 0xffff
    s_waitcnt vmcnt(5)
    s_cbranch_vccnz L_gt42
    s_waitcnt vmcnt(4)
L_gt42:
    buffer_load_dwordx4 v[104:107], v1, s[20:23], s46 offen offset:2048 nt
    v_mfma_f32_16x16x32_bf16 v[20:23], v[112:115], v[4:7], 0
    s_mov_b64 exec, 1
    ds_add_u32 v39, v61 offset:5700
    s_mov_b64 exec, -1
    s_waitcnt vmcnt(5)
    s_cbranch_vccnz L_gt43
    s_waitcnt vmcnt(4)
L_gt43:
    buffer_load_dwordx4 v[108:111], v1, s[20:23], s46 offen offset:3072 nt
    v_mfma_f32_16x16x32_bf16 v[20:23], v[116:119], v[8:11], v[20:23]
    s_waitcnt lgkmcnt(0)
    v_cmp_ne_u32 vcc, 0, v60
    ds_read_b32 v60, v39 offset:5704
    s_nop 1
    v_mov_b32_dpp v81, v24 quad_perm:[0,0,0,0] row_mask:0xf bank_mask:0xf
    v_add_f32_dpp v81, v25, v81 quad_perm:[1,1,1,1] row_mask:0xf bank_mask:0xf
    v_add_f32_dpp v81, v26, v81 quad_perm:[2,2,2,2] row_mask:0xf bank_mask:0xf
    v_add_f32_dpp v81, v27, v81 quad_perm:[3,3,3,3] row_mask:0xf bank_mask:0xf
    v_max_f32 v28, v28, v81
    v_lshlrev_b32 v31, v31, v32
    v_bfe_u32 v32, v0, 1, 2
    v_cmp_eq_u32 s[4:5], 0, v32
    v_cmp_eq_u32 s[6:7], 1, v32
    s_waitcnt vmcnt(5)
    s_cbranch_vccnz L_gt44
    s_waitcnt vmcnt(4)
L_gt44:
    s_xor_b32 s46, s43, 180224
    buffer_load_dwordx4 v[112:115], v1, s[20:23], s46 offen offset:0 nt
    v_mfma_f32_16x16x32_bf16 v[24:27], v[120:123], v[4:7], 0
    s_waitcnt vmcnt(5)
    s_cbranch_vccnz L_gt45
    s_waitcnt vmcnt(4)
L_gt45:
    buffer_load_dwordx4 v[116:119], v1, s[20:23], s46 offen offset:1024 nt
    v_mfma_f32_16x16x32_bf16 v[24:27], v[124:127], v[8:11], v[24:27]
    s_waitcnt lgkmcnt(0)
    v_cmp_ne_u32 vcc, 0, v60
    ds_read_b32 v60, v39 offset:5704
    s_nop 1
    v_mov_b32_dpp v82, v20 quad_perm:[0,0,0,0] row_mask:0xf bank_mask:0xf
    v_add_f32_dpp v82, v21, v82 quad_perm:[1,1,1,1] row_mask:0xf bank_mask:0xf
    v_add_f32_dpp v82, v22, v82 quad_perm:[2,2,2,2] row_mask:0xf bank_mask:0xf
    v_add_f32_dpp v82, v23, v82 quad_perm:[3,3,3,3] row_mask:0xf bank_mask:0xf
    v_max_f32 v28, v28, v82
    v_cmp_eq_u32 s[8:9], 2, v32
    v_cmp_eq_u32 s[10:11], 3, v32
    v_mov_b32 v16, 0
    v_mov_b32 v17, 0
    s_waitcnt vmcnt(5)
    s_cbranch_vccnz L_gt46
    s_waitcnt vmcnt(4)
L_gt46:
    buffer_load_dwordx4 v[120:123], v1, s[20:23], s46 offen offset:2048 nt
    v_mfma_f32_16x16x32_bf16 v[20:23], v[96:99], v[4:7], 0
    s_mov_b64 exec, 1
    ds_add_u32 v39, v61 offset:5700
    s_mov_b64 exec, -1
    s_waitcnt vmcnt(5)
    s_cbranch_vccnz L_gt47
    s_waitcnt vmcnt(4)
L_gt47:
    buffer_load_dwordx4 v[124:127], v1, s[20:23], s46 offen offset:3072 nt
    v_mfma_f32_16x16x32_bf16 v[20:23], v[100:103], v[8:11], v[20:23]
    s_waitcnt lgkmcnt(0)
    v_cmp_ne_u32 vcc, 0, v60
    ds_read_b32 v60, v39 offset:5704
    s_nop 1
    v_mov_b32_dpp v83, v24 quad_perm:[0,0,0,0] row_mask:0xf bank_mask:0xf
    v_add_f32_dpp v83, v25, v83 quad_perm:[1,1,1,1] row_mask:0xf bank_mask:0xf
    v_add_f32_dpp v83, v26, v83 quad_perm:[2,2,2,2] row_mask:0xf bank_mask:0xf
    v_add_f32_dpp v83, v27, v83 quad_perm:[3,3,3,3] row_mask:0xf bank_mask:0xf
    v_max_f32 v28, v28, v83
    v_cndmask_b32 v12, 0, v31, s[4:5]
    v_cndmask_b32 v13, 0, v31, s[6:7]
    v_cndmask_b32 v14, 0, v31, s[8:9]
    v_cndmask_b32 v15, 0, v31, s[10:11]
    s_waitcnt vmcnt(5)
    s_cbranch_vccnz L_gt48
    s_waitcnt vmcnt(4)
L_gt48:
    s_xor_b32 s46, s43, 196608
    buffer_load_dwordx4 v[96:99], v1, s[20:23], s46 offen offset:0 nt
    v_mfma_f32_16x16x32_bf16 v[24:27], v[104:107], v[4:7], 0
    s_waitcnt vmcnt(5)
    s_cbranch_vccnz L_gt49
    s_waitcnt vmcnt(4)
L_gt49:
    buffer_load_dwordx4 v[100:103], v1, s[20:23], s46 offen offset:1024 nt
    v_mfma_f32_16x16x32_bf16 v[24:27], v[108:111], v[8:11], v[24:27]
    s_waitcnt lgkmcnt(0)
    v_cmp_ne_u32 vcc, 0, v60
    ds_read_b32 v60, v39 offset:5704
    s_nop 1
    v_mov_b32_dpp v84, v20 quad_perm:[0,0,0,0] row_mask:0xf bank_mask:0xf
    v_add_f32_dpp v84, v21, v84 quad_perm:[1,1,1,1] row_mask:0xf bank_mask:0xf
    v_add_f32_dpp v84, v22, v84 quad_perm:[2,2,2,2] row_mask:0xf bank_mask:0xf
    v_add_f32_dpp v84, v23, v84 quad_perm:[3,3,3,3] row_mask:0xf bank_mask:0xf
    v_max_f32 v28, v28, v84
    v_mov_b32 v18, 0
    v_mov_b32 v19, 0
    v_mov_b32 v30, 0
    v_mov_b32 v44, 0
    s_waitcnt vmcnt(5)
    s_cbranch_vccnz L_gt50
    s_waitcnt vmcnt(4)
L_gt50:
    buffer_load_dwordx4 v[104:107], v1, s[20:23], s46 offen offset:2048 nt
    v_mfma_f32_16x16x32_bf16 v[20:23], v[112:115], v[4:7], 0
    s_mov_b64 exec, 1
    ds_add_u32 v39, v61 offset:5700
    s_mov_b64 exec, -1
    s_waitcnt vmcnt(5)
    s_cbranch_vccnz L_gt51
    s_waitcnt vmcnt(4)
L_gt51:
    buffer_load_dwordx4 v[108:111], v1, s[20:23], s46 offen offset:3072 nt
    v_mfma_f32_16x16x32_bf16 v[20:23], v[116:119], v[8:11], v[20:23]
    s_waitcnt lgkmcnt(0)
    v_cmp_ne_u32 vcc, 0, v60
    ds_read_b32 v60, v39 offset:5704
    s_nop 1
    v_mov_b32_dpp v85, v24 quad_perm:[0,0,0,0] row_mask:0xf bank_mask:0xf
    v_add_f32_dpp v85, v25, v85 quad_perm:[1,1,1,1] row_mask:0xf bank_mask:0xf
    v_add_f32_dpp v85, v26, v85 quad_perm:[2,2,2,2] row_mask:0xf bank_mask:0xf
    v_add_f32_dpp v85, v27, v85 quad_perm:[3,3,3,3] row_mask:0xf bank_mask:0xf
    v_max_f32 v28, v28, v85
    v_mov_b32 v45, 0
    v_mov_b32 v46, 0
    v_mov_b32 v47, 0
    v_mov_b32 v48, 0
    s_waitcnt vmcnt(5)
    s_cbranch_vccnz L_gt52
    s_waitcnt vmcnt(4)
L_gt52:
    s_xor_b32 s46, s43, 212992
    buffer_load_dwordx4 v[112:115], v1, s[20:23], s46 offen offset:0 nt
    v_mfma_f32_16x16x32_bf16 v[24:27], v[120:123], v[4:7], 0
    s_waitcnt vmcnt(5)
    s_cbranch_vccnz L_gt53
    s_waitcnt vmcnt(4)
L_gt53:
    buffer_load_dwordx4 v[116:119], v1, s[20:23], s46 offen offset:1024 nt
    v_mfma_f32_16x16x32_bf16 v[24:27], v[124:127], v[8:11], v[24:27]
    s_waitcnt lgkmcnt(0)
    v_cmp_ne_u32 vcc, 0, v60
    ds_read_b32 v60, v39 offset:5704
    s_nop 1
    v_mov_b32_dpp v86, v20 quad_perm:[0,0,0,0] row_mask:0xf bank_mask:0xf
    v_add_f32_dpp v86, v21, v86 quad_perm:[1,1,1,1] row_mask:0xf bank_mask:0xf
    v_add_f32_dpp v86, v22, v86 quad_perm:[2,2,2,2] row_mask:0xf bank_mask:0xf
    v_add_f32_dpp v86, v23, v86 quad_perm:[3,3,3,3] row_mask:0xf bank_mask:0xf
    v_max_f32 v28, v28, v86
    v_mov_b32 v49, 0
    v_mov_b32 v50, 0
    v_mov_b32 v51, 0
    v_mov_b32 v52, 0
    s_waitcnt vmcnt(5)
    s_cbranch_vccnz L_gt54
    s_waitcnt vmcnt(4)
L_gt54:
    buffer_load_dwordx4 v[120:123], v1, s[20:23], s46 offen offset:2048 nt
    v_mfma_f32_16x16x32_bf16 v[20:23], v[96:99], v[4:7], 0
    s_mov_b64 exec, 1
    ds_add_u32 v39, v61 offset:5700
    s_mov_b64 exec, -1
    s_waitcnt vmcnt(5)
    s_cbranch_vccnz L_gt55
    s_waitcnt vmcnt(4)
L_gt55:
    buffer_load_dwordx4 v[124:127], v1, s[20:23], s46 offen offset:3072 nt
    v_mfma_f32_16x16x32_bf16 v[20:23], v[100:103], v[8:11], v[20:23]
    s_waitcnt lgkmcnt(0)
    v_cmp_ne_u32 vcc, 0, v60
    ds_read_b32 v60, v39 offset:5704
    s_nop 1
    v_mov_b32_dpp v87, v24 quad_perm:[0,0,0,0] row_mask:0xf bank_mask:0xf
    v_add_f32_dpp v87, v25, v87 quad_perm:[1,1,1,1] row_mask:0xf bank_mask:0xf
    v_add_f32_dpp v87, v26, v87 quad_perm:[2,2,2,2] row_mask:0xf bank_mask:0xf
    v_add_f32_dpp v87, v27, v87 quad_perm:[3,3,3,3] row_mask:0xf bank_mask:0xf
    v_max_f32 v28, v28, v87
    v_mov_b32 v53, 0
    v_mov_b32 v54, 0
    v_mov_b32 v55, 0
    v_mov_b32 v56, 0
    s_waitcnt vmcnt(5)
    s_cbranch_vccnz L_gt56
    s_waitcnt vmcnt(4)
L_gt56:
    s_xor_b32 s46, s43, 229376
    buffer_load_dwordx4 v[96:99], v1, s[20:23], s46 offen offset:0 nt
    v_mfma_f32_16x16x32_bf16 v[24:27], v[104:107], v[4:7], 0
    s_waitcnt vmcnt(5)
    s_cbranch_vccnz L_gt57
    s_waitcnt vmcnt(4)
L_gt57:
    buffer_load_dwordx4 v[100:103], v1, s[20:23], s46 offen offset:1024 nt
    v_mfma_f32_16x16x32_bf16 v[24:27], v[108:111], v[8:11], v[24:27]
    s_waitcnt lgkmcnt(0)
    v_cmp_ne_u32 vcc, 0, v60
    ds_read_b32 v60, v39 offset:5704
    s_nop 1
    v_mov_b32_dpp v88, v20 quad_perm:[0,0,0,0] row_mask:0xf bank_mask:0xf
    v_add_f32_dpp v88, v21, v88 quad_perm:[1,1,1,1] row_mask:0xf bank_mask:0xf
    v_add_f32_dpp v88, v22, v88 quad_perm:[2,2,2,2] row_mask:0xf bank_mask:0xf
    v_add_f32_dpp v88, v23, v88 quad_perm:[3,3,3,3] row_mask:0xf bank_mask:0xf
    v_max_f32 v28, v28, v88
    v_mov_b32 v57, 0
    v_mov_b32 v58, 0
    v_mov_b32 v59, 0
    s_waitcnt vmcnt(5)
    s_cbranch_vccnz L_gt58
    s_waitcnt vmcnt(4)
L_gt58:
    buffer_load_dwordx4 v[104:107], v1, s[20:23], s46 offen offset:2048 nt
    v_mfma_f32_16x16x32_bf16 v[20:23], v[112:115], v[4:7], 0
    s_mov_b64 exec, 1
    ds_add_u32 v39, v61 offset:5700
    s_mov_b64 exec, -1
    s_waitcnt vmcnt(5)
    s_cbranch_vccnz L_gt59
    s_waitcnt vmcnt(4)
L_gt59:
    buffer_load_dwordx4 v[108:111], v1, s[20:23], s46 offen offset:3072 nt
    v_mfma_f32_16x16x32_bf16 v[20:23], v[116:119], v[8:11], v[20:23]
    s_waitcnt lgkmcnt(0)
    v_cmp_ne_u32 vcc, 0, v60
    ds_read_b32 v60, v39 offset:5704
    s_nop 1
    v_mov_b32_dpp v89, v24 quad_perm:[0,0,0,0] row_mask:0xf bank_mask:0xf
    v_add_f32_dpp v89, v25, v89 quad_perm:[1,1,1,1] row_mask:0xf bank_mask:0xf
    v_add_f32_dpp v89, v26, v89 quad_perm:[2,2,2,2] row_mask:0xf bank_mask:0xf
    v_add_f32_dpp v89, v27, v89 quad_perm:[3,3,3,3] row_mask:0xf bank_mask:0xf
    v_max_f32 v28, v28, v89
    s_waitcnt vmcnt(5)
    s_cbranch_vccnz L_gt60
    s_waitcnt vmcnt(4)
L_gt60:
    s_xor_b32 s46, s43, 245760
    buffer_load_dwordx4 v[112:115], v1, s[20:23], s46 offen offset:0 nt
    v_mfma_f32_16x16x32_bf16 v[24:27], v[120:123], v[4:7], 0
    s_waitcnt vmcnt(5)
    s_cbranch_vccnz L_gt61
    s_waitcnt vmcnt(4)
L_gt61:
    buffer_load_dwordx4 v[116:119], v1, s[20:23], s46 offen offset:1024 nt
    v_mfma_f32_16x16x32_bf16 v[24:27], v[124:127], v[8:11], v[24:27]
    s_waitcnt lgkmcnt(0)
    v_cmp_ne_u32 vcc, 0, v60
    ds_read_b32 v60, v39 offset:5704
    s_nop 1
    v_mov_b32_dpp v90, v20 quad_perm:[0,0,0,0] row_mask:0xf bank_mask:0xf
    v_add_f32_dpp v90, v21, v90 quad_perm:[1,1,1,1] row_mask:0xf bank_mask:0xf
    v_add_f32_dpp v90, v22, v90 quad_perm:[2,2,2,2] row_mask:0xf bank_mask:0xf
    v_add_f32_dpp v90, v23, v90 quad_perm:[3,3,3,3] row_mask:0xf bank_mask:0xf
    v_max_f32 v28, v28, v90
    s_waitcnt vmcnt(5)
    s_cbranch_vccnz L_gt62
    s_waitcnt vmcnt(4)
L_gt62:
    buffer_load_dwordx4 v[120:123], v1, s[20:23], s46 offen offset:2048 nt
    v_mfma_f32_16x16x32_bf16 v[20:23], v[96:99], v[4:7], 0
    s_mov_b64 exec, 1
    ds_add_u32 v39, v61 offset:5700
    s_mov_b64 exec, -1
    s_waitcnt vmcnt(5)
    s_cbranch_vccnz L_gt63
    s_waitcnt vmcnt(4)
L_gt63:
    buffer_load_dwordx4 v[124:127], v1, s[20:23], s46 offen offset:3072 nt
    v_mfma_f32_16x16x32_bf16 v[20:23], v[100:103], v[8:11], v[20:23]
    s_waitcnt lgkmcnt(0)
    v_cmp_ne_u32 vcc, 0, v60
    ds_read_b32 v60, v39 offset:5704
    s_nop 1
    v_mov_b32_dpp v91, v24 quad_perm:[0,0,0,0] row_mask:0xf bank_mask:0xf
    v_add_f32_dpp v91, v25, v91 quad_perm:[1,1,1,1] row_mask:0xf bank_mask:0xf
    v_add_f32_dpp v91, v26, v91 quad_perm:[2,2,2,2] row_mask:0xf bank_mask:0xf
    v_add_f32_dpp v91, v27, v91 quad_perm:[3,3,3,3] row_mask:0xf bank_mask:0xf
    v_max_f32 v28, v28, v91
    s_waitcnt vmcnt(5)
    s_cbranch_vccnz L_gt64
    s_waitcnt vmcnt(4)
L_gt64:
    s_mov_b32 s46, s43
    buffer_load_dwordx4 v[96:99], v2, s[24:27], s46 offen offset:0 nt
    v_mfma_f32_16x16x32_bf16 v[24:27], v[104:107], v[4:7], 0
    s_waitcnt vmcnt(5)
    s_cbranch_vccnz L_gt65
    s_waitcnt vmcnt(4)
L_gt65:
    buffer_load_dwordx4 v[100:103], v2, s[24:27], s46 offen offset:1024 nt
    v_mfma_f32_16x16x32_bf16 v[24:27], v[108:111], v[8:11], v[24:27]
    s_waitcnt lgkmcnt(0)
    v_cmp_ne_u32 vcc, 0, v60
    ds_read_b32 v60, v39 offset:5704
    s_nop 1
    v_mov_b32_dpp v92, v20 quad_perm:[0,0,0,0] row_mask:0xf bank_mask:0xf
    v_add_f32_dpp v92, v21, v92 quad_perm:[1,1,1,1] row_mask:0xf bank_mask:0xf
    v_add_f32_dpp v92, v22, v92 quad_perm:[2,2,2,2] row_mask:0xf bank_mask:0xf
    v_add_f32_dpp v92, v23, v92 quad_perm:[3,3,3,3] row_mask:0xf bank_mask:0xf
    v_max_f32 v28, v28, v92
    s_waitcnt vmcnt(5)
    s_cbranch_vccnz L_gt66
    s_waitcnt vmcnt(4)
L_gt66:
    buffer_load_dwordx4 v[104:107], v2, s[24:27], s46 offen offset:2048 nt
    v_mfma_f32_16x16x32_bf16 v[20:23], v[112:115], v[4:7], 0
    s_mov_b64 exec, 1
    ds_add_u32 v39, v61 offset:5700
    s_mov_b64 exec, -1
    s_waitcnt vmcnt(5)
    s_cbranch_vccnz L_gt67
    s_waitcnt vmcnt(4)
L_gt67:
    buffer_load_dwordx4 v[108:111], v2, s[24:27], s46 offen offset:3072 nt
    v_mfma_f32_16x16x32_bf16 v[20:23], v[116:119], v[8:11], v[20:23]
    s_waitcnt lgkmcnt(0)
    v_cmp_ne_u32 vcc, 0, v60
    ds_read_b32 v60, v39 offset:5704
    s_nop 1
    v_mov_b32_dpp v93, v24 quad_perm:[0,0,0,0] row_mask:0xf bank_mask:0xf
    v_add_f32_dpp v93, v25, v93 quad_perm:[1,1,1,1] row_mask:0xf bank_mask:0xf
    v_add_f32_dpp v93, v26, v93 quad_perm:[2,2,2,2] row_mask:0xf bank_mask:0xf
    v_add_f32_dpp v93, v27, v93 quad_perm:[3,3,3,3] row_mask:0xf bank_mask:0xf
    v_max_f32 v28, v28, v93
    s_waitcnt vmcnt(5)
    s_cbranch_vccnz L_gt68
    s_waitcnt vmcnt(4)
L_gt68:
    s_xor_b32 s46, s43, 16384
    buffer_load_dwordx4 v[112:115], v2, s[24:27], s46 offen offset:0 nt
    v_mfma_f32_16x16x32_bf16 v[24:27], v[120:123], v[4:7], 0
    s_waitcnt vmcnt(5)
    s_cbranch_vccnz L_gt69
    s_waitcnt vmcnt(4)
L_gt69:
    buffer_load_dwordx4 v[116:119], v2, s[24:27], s46 offen offset:1024 nt
    v_mfma_f32_16x16x32_bf16 v[24:27], v[124:127], v[8:11], v[24:27]
    s_waitcnt lgkmcnt(0)
    v_cmp_ne_u32 vcc, 0, v60
    ds_read_b32 v60, v39 offset:5704
    s_nop 1
    v_mov_b32_dpp v94, v20 quad_perm:[0,0,0,0] row_mask:0xf bank_mask:0xf
    v_add_f32_dpp v94, v21, v94 quad_perm:[1,1,1,1] row_mask:0xf bank_mask:0xf
    v_add_f32_dpp v94, v22, v94 quad_perm:[2,2,2,2] row_mask:0xf bank_mask:0xf
    v_add_f32_dpp v94, v23, v94 quad_perm:[3,3,3,3] row_mask:0xf bank_mask:0xf
    v_max_f32 v28, v28, v94
    s_nop 2
    v_mov_b32_dpp v95, v24 quad_perm:[0,0,0,0] row_mask:0xf bank_mask:0xf
    v_add_f32_dpp v95, v25, v95 quad_perm:[1,1,1,1] row_mask:0xf bank_mask:0xf
    v_add_f32_dpp v95, v26, v95 quad_perm:[2,2,2,2] row_mask:0xf bank_mask:0xf
    v_add_f32_dpp v95, v27, v95 quad_perm:[3,3,3,3] row_mask:0xf bank_mask:0xf
    v_max_f32 v28, v28, v95
    s_nop 1
    v_max_f32_dpp v28, v28, v28 row_half_mirror row_mask:0xf bank_mask:0xf
    v_mov_b32 v3, v28
    s_nop 1
    v_permlane16_swap_b32 v28, v3
    v_max_f32 v28, v28, v3
    v_mov_b32 v3, v28
    s_nop 1
    v_permlane32_swap_b32 v28, v3
    v_max_f32 v28, v28, v3
    v_mul_f32 v28, s45, v28
    v_lshrrev_b32 v32, 1, v35
    s_mov_b64 exec, 0x101
    ds_write_b32 v32, v28 offset:5712
    s_mov_b64 exec, 1
    ds_add_u32 v39, v61 offset:5708
    s_mov_b64 exec, -1
    v_and_b32 v32, 16, v32
    v_fma_f32 v64, v64, s45, -v28
    v_exp_f32 v64, v64
    s_nop 0
    v_add_f32 v30, v30, v64
    v_cvt_pk_bf16_f32 v64, v64, v64
    v_fma_f32 v65, v65, s45, -v28
    v_exp_f32 v65, v65
    s_nop 0
    v_add_f32 v30, v30, v65
    v_cvt_pk_bf16_f32 v65, v65, v65
    v_and_b32 v20, v64, v12
    v_and_b32 v21, v64, v13
    v_and_b32_dpp v22, v64, v14 row_shr:4 row_mask:0xf bank_mask:0xf bound_ctrl:0
    v_and_b32_dpp v23, v64, v15 row_shr:4 row_mask:0xf bank_mask:0xf bound_ctrl:0
    s_waitcnt vmcnt(5)
    s_cbranch_vccnz L_gt70
    s_waitcnt vmcnt(4)
L_gt70:
    buffer_load_dwordx4 v[120:123], v2, s[24:27], s46 offen offset:2048 nt
    v_mfma_f32_16x16x32_bf16 v[16:19], v[96:99], v[20:23], v[16:19]
    s_mov_b64 exec, 1
    ds_add_u32 v39, v61 offset:5700
    s_mov_b64 exec, -1
    v_and_b32_dpp v24, v64, v12 row_shl:4 row_mask:0xf bank_mask:0xf bound_ctrl:0
    v_and_b32_dpp v25, v64, v13 row_shl:4 row_mask:0xf bank_mask:0xf bound_ctrl:0
    v_and_b32 v26, v64, v14
    v_and_b32 v27, v64, v15
    s_waitcnt vmcnt(5)
    s_cbranch_vccnz L_gt71
    s_waitcnt vmcnt(4)
L_gt71:
    buffer_load_dwordx4 v[124:127], v2, s[24:27], s46 offen offset:3072 nt
    v_mfma_f32_16x16x32_bf16 v[16:19], v[100:103], v[24:27], v[16:19]
    s_waitcnt lgkmcnt(0)
    v_cmp_ne_u32 vcc, 0, v60
    ds_read_b32 v60, v39 offset:5704
    v_fma_f32 v66, v66, s45, -v28
    v_exp_f32 v66, v66
    s_nop 0
    v_add_f32 v30, v30, v66
    v_cvt_pk_bf16_f32 v66, v66, v66
    v_and_b32 v20, v65, v12
    v_and_b32 v21, v65, v13
    v_and_b32_dpp v22, v65, v14 row_shr:4 row_mask:0xf bank_mask:0xf bound_ctrl:0
    v_and_b32_dpp v23, v65, v15 row_shr:4 row_mask:0xf bank_mask:0xf bound_ctrl:0
    s_waitcnt vmcnt(5)
    s_cbranch_vccnz L_gt72
    s_waitcnt vmcnt(4)
L_gt72:
    s_xor_b32 s46, s43, 32768
    buffer_load_dwordx4 v[96:99], v2, s[24:27], s46 offen offset:0 nt
    v_mfma_f32_16x16x32_bf16 v[16:19], v[104:107], v[20:23], v[16:19]
    v_and_b32_dpp v24, v65, v12 row_shl:4 row_mask:0xf bank_mask:0xf bound_ctrl:0
    v_and_b32_dpp v25, v65, v13 row_shl:4 row_mask:0xf bank_mask:0xf bound_ctrl:0
    v_and_b32 v26, v65, v14
    v_and_b32 v27, v65, v15
    s_waitcnt vmcnt(5)
    s_cbranch_vccnz L_gt73
    s_waitcnt vmcnt(4)
L_gt73:
    buffer_load_dwordx4 v[100:103], v2, s[24:27], s46 offen offset:1024 nt
    v_mfma_f32_16x16x32_bf16 v[16:19], v[108:111], v[24:27], v[16:19]
    s_waitcnt lgkmcnt(0)
    v_cmp_ne_u32 vcc, 0, v60
    ds_read_b32 v60, v39 offset:5704
    v_fma_f32 v67, v67, s45, -v28
    v_exp_f32 v67, v67
    s_nop 0
    v_add_f32 v30, v30, v67
    v_cvt_pk_bf16_f32 v67, v67, v67
    v_and_b32 v20, v66, v12
    v_and_b32 v21, v66, v13
    v_and_b32_dpp v22, v66, v14 row_shr:4 row_mask:0xf bank_mask:0xf bound_ctrl:0
    v_and_b32_dpp v23, v66, v15 row_shr:4 row_mask:0xf bank_mask:0xf bound_ctrl:0
    s_waitcnt vmcnt(5)
    s_cbranch_vccnz L_gt74
    s_waitcnt vmcnt(4)
L_gt74:
    buffer_load_dwordx4 v[104:107], v2, s[24:27], s46 offen offset:2048 nt
    v_mfma_f32_16x16x32_bf16 v[16:19], v[112:115], v[20:23], v[16:19]
    s_mov_b64 exec, 1
    ds_add_u32 v39, v61 offset:5700
    s_mov_b64 exec, -1
    v_and_b32_dpp v24, v66, v12 row_shl:4 row_mask:0xf bank_mask:0xf bound_ctrl:0
    v_and_b32_dpp v25, v66, v13 row_shl:4 row_mask:0xf bank_mask:0xf bound_ctrl:0
    v_and_b32 v26, v66, v14
    v_and_b32 v27, v66, v15
    s_waitcnt vmcnt(5)
    s_cbranch_vccnz L_gt75
    s_waitcnt vmcnt(4)
L_gt75:
    buffer_load_dwordx4 v[108:111], v2, s[24:27], s46 offen offset:3072 nt
    v_mfma_f32_16x16x32_bf16 v[16:19], v[116:119], v[24:27], v[16:19]
    s_waitcnt lgkmcnt(0)
    v_cmp_ne_u32 vcc, 0, v60
    ds_read_b32 v60, v39 offset:5704
    v_fma_f32 v68, v68, s45, -v28
    v_exp_f32 v68, v68
    s_nop 0
    v_add_f32 v30, v30, v68
    v_cvt_pk_bf16_f32 v68, v68, v68
    v_and_b32 v20, v67, v12
    v_and_b32 v21, v67, v13
    v_and_b32_dpp v22, v67, v14 row_shr:4 row_mask:0xf bank_mask:0xf bound_ctrl:0
    v_and_b32_dpp v23, v67, v15 row_shr:4 row_mask:0xf bank_mask:0xf bound_ctrl:0
    s_waitcnt vmcnt(5)
    s_cbranch_vccnz L_gt76
    s_waitcnt vmcnt(4)
L_gt76:
    s_xor_b32 s46, s43, 49152
    buffer_load_dwordx4 v[112:115], v2, s[24:27], s46 offen offset:0 nt
    v_mfma_f32_16x16x32_bf16 v[16:19], v[120:123], v[20:23], v[16:19]
    v_and_b32_dpp v24, v67, v12 row_shl:4 row_mask:0xf bank_mask:0xf bound_ctrl:0
    v_and_b32_dpp v25, v67, v13 row_shl:4 row_mask:0xf bank_mask:0xf bound_ctrl:0
    v_and_b32 v26, v67, v14
    v_and_b32 v27, v67, v15
    s_waitcnt vmcnt(5)
    s_cbranch_vccnz L_gt77
    s_waitcnt vmcnt(4)
L_gt77:
    buffer_load_dwordx4 v[116:119], v2, s[24:27], s46 offen offset:1024 nt
    v_mfma_f32_16x16x32_bf16 v[16:19], v[124:127], v[24:27], v[16:19]
    s_waitcnt lgkmcnt(0)
    v_cmp_ne_u32 vcc, 0, v60
    ds_read_b32 v60, v39 offset:5704
    v_fma_f32 v69, v69, s45, -v28
    v_exp_f32 v69, v69
    s_nop 0
    v_add_f32 v30, v30, v69
    v_cvt_pk_bf16_f32 v69, v69, v69
    v_and_b32 v20, v68, v12
    v_and_b32 v21, v68, v13
    v_and_b32_dpp v22, v68, v14 row_shr:4 row_mask:0xf bank_mask:0xf bound_ctrl:0
    v_and_b32_dpp v23, v68, v15 row_shr:4 row_mask:0xf bank_mask:0xf bound_ctrl:0
    s_waitcnt vmcnt(5)
    s_cbranch_vccnz L_gt78
    s_waitcnt vmcnt(4)
L_gt78:
    buffer_load_dwordx4 v[120:123], v2, s[24:27], s46 offen offset:2048 nt
    v_mfma_f32_16x16x32_bf16 v[16:19], v[96:99], v[20:23], v[16:19]
    s_mov_b64 exec, 1
    ds_add_u32 v39, v61 offset:5700
    s_mov_b64 exec, -1
    v_and_b32_dpp v24, v68, v12 row_shl:4 row_mask:0xf bank_mask:0xf bound_ctrl:0
    v_and_b32_dpp v25, v68, v13 row_shl:4 row_mask:0xf bank_mask:0xf bound_ctrl:0
    v_and_b32 v26, v68, v14
    v_and_b32 v27, v68, v15
    s_waitcnt vmcnt(5)
    s_cbranch_vccnz L_gt79
    s_waitcnt vmcnt(4)
L_gt79:
    buffer_load_dwordx4 v[124:127], v2, s[24:27], s46 offen offset:3072 nt
    v_mfma_f32_16x16x32_bf16 v[16:19], v[100:103], v[24:27], v[16:19]
    s_waitcnt lgkmcnt(0)
    v_cmp_ne_u32 vcc, 0, v60
    ds_read_b32 v60, v39 offset:5704
    ds_read_b32 v33, v39 offset:5708
    ds_read_b128 v[4:7], v32 offset:5712
    v_fma_f32 v70, v70, s45, -v28
    v_exp_f32 v70, v70
    s_nop 0
    v_add_f32 v30, v30, v70
    v_cvt_pk_bf16_f32 v70, v70, v70
    v_and_b32 v20, v69, v12
    v_and_b32 v21, v69, v13
    v_and_b32_dpp v22, v69, v14 row_shr:4 row_mask:0xf bank_mask:0xf bound_ctrl:0
    v_and_b32_dpp v23, v69, v15 row_shr:4 row_mask:0xf bank_mask:0xf bound_ctrl:0
    s_waitcnt vmcnt(5)
    s_cbranch_vccnz L_gt80
    s_waitcnt vmcnt(4)
L_gt80:
    s_xor_b32 s46, s43, 65536
    buffer_load_dwordx4 v[96:99], v2, s[24:27], s46 offen offset:0 nt
    v_mfma_f32_16x16x32_bf16 v[16:19], v[104:107], v[20:23], v[16:19]
    v_and_b32_dpp v24, v69, v12 row_shl:4 row_mask:0xf bank_mask:0xf bound_ctrl:0
    v_and_b32_dpp v25, v69, v13 row_shl:4 row_mask:0xf bank_mask:0xf bound_ctrl:0
    v_and_b32 v26, v69, v14
    v_and_b32 v27, v69, v15
    s_waitcnt vmcnt(5)
    s_cbranch_vccnz L_gt81
    s_waitcnt vmcnt(4)
L_gt81:
    buffer_load_dwordx4 v[100:103], v2, s[24:27], s46 offen offset:1024 nt
    v_mfma_f32_16x16x32_bf16 v[16:19], v[108:111], v[24:27], v[16:19]
    s_waitcnt lgkmcnt(0)
    v_cmp_ne_u32 vcc, 0, v60
    ds_read_b32 v60, v39 offset:5704
    v_and_b32 v20, v70, v12
    v_and_b32 v21, v70, v13
    v_and_b32_dpp v22, v70, v14 row_shr:4 row_mask:0xf bank_mask:0xf bound_ctrl:0
    v_and_b32_dpp v23, v70, v15 row_shr:4 row_mask:0xf bank_mask:0xf bound_ctrl:0
    s_waitcnt vmcnt(5)
    s_cbranch_vccnz L_gt82
    s_waitcnt vmcnt(4)
L_gt82:
    buffer_load_dwordx4 v[104:107], v2, s[24:27], s46 offen offset:2048 nt
    v_mfma_f32_16x16x32_bf16 v[16:19], v[112:115], v[20:23], v[16:19]
    s_mov_b64 exec, 1
    ds_add_u32 v39, v61 offset:5700
    s_mov_b64 exec, -1
    v_and_b32_dpp v24, v70, v12 row_shl:4 row_mask:0xf bank_mask:0xf bound_ctrl:0
    v_and_b32_dpp v25, v70, v13 row_shl:4 row_mask:0xf bank_mask:0xf bound_ctrl:0
    v_and_b32 v26, v70, v14
    v_and_b32 v27, v70, v15
    s_waitcnt vmcnt(5)
    s_cbranch_vccnz L_gt83
    s_waitcnt vmcnt(4)
L_gt83:
    buffer_load_dwordx4 v[108:111], v2, s[24:27], s46 offen offset:3072 nt
    v_mfma_f32_16x16x32_bf16 v[16:19], v[116:119], v[24:27], v[16:19]
    s_waitcnt lgkmcnt(0)
    v_cmp_ne_u32 vcc, 0, v60
    ds_read_b32 v60, v39 offset:5704
L_sw:
    s_waitcnt lgkmcnt(0)
    v_readfirstlane_b32 s4, v33
    v_max3_f32 v3, v4, v5, v6
    s_cmp_ge_u32 s4, 4
    s_cbranch_scc1 L_sw2
    ds_read_b32 v33, v39 offset:5708
    ds_read_b128 v[4:7], v32 offset:5712
    s_branch L_sw
L_sw2:
    v_max_f32 v3, v3, v7
    v_sub_f32 v31, v28, v3
    v_exp_f32 v31, v31
    v_mov_b32 v28, v3
    v_mul_f32 v30, v30, v31
    v_mul_f32 v16, v16, v31
    v_mul_f32 v17, v17, v31
    v_mul_f32 v18, v18, v31
    v_mul_f32 v19, v19, v31
    v_fma_f32 v71, v71, s45, -v28
    v_exp_f32 v71, v71
    s_nop 0
    v_add_f32 v30, v30, v71
    v_cvt_pk_bf16_f32 v71, v71, v71
    v_fma_f32 v72, v72, s45, -v28
    v_exp_f32 v72, v72
    s_nop 0
    v_add_f32 v30, v30, v72
    v_cvt_pk_bf16_f32 v72, v72, v72
    v_and_b32 v20, v71, v12
    v_and_b32 v21, v71, v13
    v_and_b32_dpp v22, v71, v14 row_shr:4 row_mask:0xf bank_mask:0xf bound_ctrl:0
    v_and_b32_dpp v23, v71, v15 row_shr:4 row_mask:0xf bank_mask:0xf bound_ctrl:0
    s_waitcnt vmcnt(5)
    s_cbranch_vccnz L_gt84
    s_waitcnt vmcnt(4)
L_gt84:
    s_xor_b32 s46, s43, 81920
    buffer_load_dwordx4 v[112:115], v2, s[24:27], s46 offen offset:0 nt
    v_mfma_f32_16x16x32_bf16 v[16:19], v[120:123], v[20:23], v[16:19]
    v_fma_f32 v73, v73, s45, -v28
    v_exp_f32 v73, v73
    s_nop 0
    v_add_f32 v30, v30, v73
    v_cvt_pk_bf16_f32 v73, v73, v73
    v_and_b32_dpp v24, v71, v12 row_shl:4 row_mask:0xf bank_mask:0xf bound_ctrl:0
    v_and_b32_dpp v25, v71, v13 row_shl:4 row_mask:0xf bank_mask:0xf bound_ctrl:0
    v_and_b32 v26, v71, v14
    v_and_b32 v27, v71, v15
    s_waitcnt vmcnt(5)
    s_cbranch_vccnz L_gt85
    s_waitcnt vmcnt(4)
L_gt85:
    buffer_load_dwordx4 v[116:119], v2, s[24:27], s46 offen offset:1024 nt
    v_mfma_f32_16x16x32_bf16 v[16:19], v[124:127], v[24:27], v[16:19]
    s_waitcnt lgkmcnt(0)
    v_cmp_ne_u32 vcc, 0, v60
    ds_read_b32 v60, v39 offset:5704
    v_fma_f32 v74, v74, s45, -v28
    v_exp_f32 v74, v74
    s_nop 0
    v_add_f32 v30, v30, v74
    v_cvt_pk_bf16_f32 v74, v74, v74
    v_and_b32 v20, v72, v12
    v_and_b32 v21, v72, v13
    v_and_b32_dpp v22, v72, v14 row_shr:4 row_mask:0xf bank_mask:0xf bound_ctrl:0
    v_and_b32_dpp v23, v72, v15 row_shr:4 row_mask:0xf bank_mask:0xf bound_ctrl:0
    s_waitcnt vmcnt(5)
    s_cbranch_vccnz L_gt86
    s_waitcnt vmcnt(4)
L_gt86:
    buffer_load_dwordx4 v[120:123], v2, s[24:27], s46 offen offset:2048 nt
    v_mfma_f32_16x16x32_bf16 v[16:19], v[96:99], v[20:23], v[16:19]
    s_mov_b64 exec, 1
    ds_add_u32 v39, v61 offset:5700
    s_mov_b64 exec, -1
    v_fma_f32 v75, v75, s45, -v28
    v_exp_f32 v75, v75
    s_nop 0
    v_add_f32 v30, v30, v75
    v_cvt_pk_bf16_f32 v75, v75, v75
    v_and_b32_dpp v24, v72, v12 row_shl:4 row_mask:0xf bank_mask:0xf bound_ctrl:0
    v_and_b32_dpp v25, v72, v13 row_shl:4 row_mask:0xf bank_mask:0xf bound_ctrl:0
    v_and_b32 v26, v72, v14
    v_and_b32 v27, v72, v15
    s_waitcnt vmcnt(5)
    s_cbranch_vccnz L_gt87
    s_waitcnt vmcnt(4)
L_gt87:
    buffer_load_dwordx4 v[124:127], v2, s[24:27], s46 offen offset:3072 nt
    v_mfma_f32_16x16x32_bf16 v[16:19], v[100:103], v[24:27], v[16:19]
    s_waitcnt lgkmcnt(0)
    v_cmp_ne_u32 vcc, 0, v60
    ds_read_b32 v60, v39 offset:5704
    v_fma_f32 v76, v76, s45, -v28
    v_exp_f32 v76, v76
    s_nop 0
    v_add_f32 v30, v30, v76
    v_cvt_pk_bf16_f32 v76, v76, v76
    v_and_b32 v20, v73, v12
    v_and_b32 v21, v73, v13
    v_and_b32_dpp v22, v73, v14 row_shr:4 row_mask:0xf bank_mask:0xf bound_ctrl:0
    v_and_b32_dpp v23, v73, v15 row_shr:4 row_mask:0xf bank_mask:0xf bound_ctrl:0
    s_waitcnt vmcnt(5)
    s_cbranch_vccnz L_gt88
    s_waitcnt vmcnt(4)
L_gt88:
    s_xor_b32 s46, s43, 98304
    buffer_load_dwordx4 v[96:99], v2, s[24:27], s46 offen offset:0 nt
    v_mfma_f32_16x16x32_bf16 v[16:19], v[104:107], v[20:23], v[16:19]
    v_fma_f32 v77, v77, s45, -v28
    v_exp_f32 v77, v77
    s_nop 0
    v_add_f32 v30, v30, v77
    v_cvt_pk_bf16_f32 v77, v77, v77
    v_and_b32_dpp v24, v73, v12 row_shl:4 row_mask:0xf bank_mask:0xf bound_ctrl:0
    v_and_b32_dpp v25, v73, v13 row_shl:4 row_mask:0xf bank_mask:0xf bound_ctrl:0
    v_and_b32 v26, v73, v14
    v_and_b32 v27, v73, v15
    s_waitcnt vmcnt(5)
    s_cbranch_vccnz L_gt89
    s_waitcnt vmcnt(4)
L_gt89:
    buffer_load_dwordx4 v[100:103], v2, s[24:27], s46 offen offset:1024 nt
    v_mfma_f32_16x16x32_bf16 v[16:19], v[108:111], v[24:27], v[16:19]
    s_waitcnt lgkmcnt(0)
    v_cmp_ne_u32 vcc, 0, v60
    ds_read_b32 v60, v39 offset:5704
    v_fma_f32 v78, v78, s45, -v28
    v_exp_f32 v78, v78
    s_nop 0
    v_add_f32 v30, v30, v78
    v_cvt_pk_bf16_f32 v78, v78, v78
    v_and_b32 v20, v74, v12
    v_and_b32 v21, v74, v13
    v_and_b32_dpp v22, v74, v14 row_shr:4 row_mask:0xf bank_mask:0xf bound_ctrl:0
    v_and_b32_dpp v23, v74, v15 row_shr:4 row_mask:0xf bank_mask:0xf bound_ctrl:0
    s_waitcnt vmcnt(5)
    s_cbranch_vccnz L_gt90
    s_waitcnt vmcnt(4)
L_gt90:
    buffer_load_dwordx4 v[104:107], v2, s[24:27], s46 offen offset:2048 nt
    v_mfma_f32_16x16x32_bf16 v[16:19], v[112:115], v[20:23], v[16:19]
    s_mov_b64 exec, 1
    ds_add_u32 v39, v61 offset:5700
    s_mov_b64 exec, -1
    v_fma_f32 v79, v79, s45, -v28
    v_exp_f32 v79, v79
    s_nop 0
    v_add_f32 v30, v30, v79
    v_cvt_pk_bf16_f32 v79, v79, v79
    v_and_b32_dpp v24, v74, v12 row_shl:4 row_mask:0xf bank_mask:0xf bound_ctrl:0
    v_and_b32_dpp v25, v74, v13 row_shl:4 row_mask:0xf bank_mask:0xf bound_ctrl:0
    v_and_b32 v26, v74, v14
    v_and_b32 v27, v74, v15
    s_waitcnt vmcnt(5)
    s_cbranch_vccnz L_gt91
    s_waitcnt vmcnt(4)
L_gt91:
    buffer_load_dwordx4 v[108:111], v2, s[24:27], s46 offen offset:3072 nt
    v_mfma_f32_16x16x32_bf16 v[16:19], v[116:119], v[24:27], v[16:19]
    s_waitcnt lgkmcnt(0)
    v_cmp_ne_u32 vcc, 0, v60
    ds_read_b32 v60, v39 offset:5704
    v_fma_f32 v80, v80, s45, -v28
    v_exp_f32 v80, v80
    s_nop 0
    v_add_f32 v30, v30, v80
    v_cvt_pk_bf16_f32 v80, v80, v80
    v_and_b32 v20, v75, v12
    v_and_b32 v21, v75, v13
    v_and_b32_dpp v22, v75, v14 row_shr:4 row_mask:0xf bank_mask:0xf bound_ctrl:0
    v_and_b32_dpp v23, v75, v15 row_shr:4 row_mask:0xf bank_mask:0xf bound_ctrl:0
    s_waitcnt vmcnt(5)
    s_cbranch_vccnz L_gt92
    s_waitcnt vmcnt(4)
L_gt92:
    s_xor_b32 s46, s43, 114688
    buffer_load_dwordx4 v[112:115], v2, s[24:27], s46 offen offset:0 nt
    v_mfma_f32_16x16x32_bf16 v[16:19], v[120:123], v[20:23], v[16:19]
    v_fma_f32 v81, v81, s45, -v28
    v_exp_f32 v81, v81
    s_nop 0
    v_add_f32 v30, v30, v81
    v_cvt_pk_bf16_f32 v81, v81, v81
    v_and_b32_dpp v24, v75, v12 row_shl:4 row_mask:0xf bank_mask:0xf bound_ctrl:0
    v_and_b32_dpp v25, v75, v13 row_shl:4 row_mask:0xf bank_mask:0xf bound_ctrl:0
    v_and_b32 v26, v75, v14
    v_and_b32 v27, v75, v15
    s_waitcnt vmcnt(5)
    s_cbranch_vccnz L_gt93
    s_waitcnt vmcnt(4)
L_gt93:
    buffer_load_dwordx4 v[116:119], v2, s[24:27], s46 offen offset:1024 nt
    v_mfma_f32_16x16x32_bf16 v[16:19], v[124:127], v[24:27], v[16:19]
    s_waitcnt lgkmcnt(0)
    v_cmp_ne_u32 vcc, 0, v60
    ds_read_b32 v60, v39 offset:5704
    v_fma_f32 v82, v82, s45, -v28
    v_exp_f32 v82, v82
    s_nop 0
    v_add_f32 v30, v30, v82
    v_cvt_pk_bf16_f32 v82, v82, v82
    v_and_b32 v20, v76, v12
    v_and_b32 v21, v76, v13
    v_and_b32_dpp v22, v76, v14 row_shr:4 row_mask:0xf bank_mask:0xf bound_ctrl:0
    v_and_b32_dpp v23, v76, v15 row_shr:4 row_mask:0xf bank_mask:0xf bound_ctrl:0
    s_waitcnt vmcnt(5)
    s_cbranch_vccnz L_gt94
    s_waitcnt vmcnt(4)
L_gt94:
    buffer_load_dwordx4 v[120:123], v2, s[24:27], s46 offen offset:2048 nt
    v_mfma_f32_16x16x32_bf16 v[16:19], v[96:99], v[20:23], v[16:19]
    s_mov_b64 exec, 1
    ds_add_u32 v39, v61 offset:5700
    s_mov_b64 exec, -1
    v_fma_f32 v83, v83, s45, -v28
    v_exp_f32 v83, v83
    s_nop 0
    v_add_f32 v30, v30, v83
    v_cvt_pk_bf16_f32 v83, v83, v83
    v_and_b32_dpp v24, v76, v12 row_shl:4 row_mask:0xf bank_mask:0xf bound_ctrl:0
    v_and_b32_dpp v25, v76, v13 row_shl:4 row_mask:0xf bank_mask:0xf bound_ctrl:0
    v_and_b32 v26, v76, v14
    v_and_b32 v27, v76, v15
    s_waitcnt vmcnt(5)
    s_cbranch_vccnz L_gt95
    s_waitcnt vmcnt(4)
L_gt95:
    buffer_load_dwordx4 v[124:127], v2, s[24:27], s46 offen offset:3072 nt
    v_mfma_f32_16x16x32_bf16 v[16:19], v[100:103], v[24:27], v[16:19]
    s_waitcnt lgkmcnt(0)
    v_cmp_ne_u32 vcc, 0, v60
    ds_read_b32 v60, v39 offset:5704
    v_fma_f32 v84, v84, s45, -v28
    v_exp_f32 v84, v84
    s_nop 0
    v_add_f32 v30, v30, v84
    v_cvt_pk_bf16_f32 v84, v84, v84
    v_and_b32 v20, v77, v12
    v_and_b32 v21, v77, v13
    v_and_b32_dpp v22, v77, v14 row_shr:4 row_mask:0xf bank_mask:0xf bound_ctrl:0
    v_and_b32_dpp v23, v77, v15 row_shr:4 row_mask:0xf bank_mask:0xf bound_ctrl:0
    s_waitcnt vmcnt(5)
    s_cbranch_vccnz L_gt96
    s_waitcnt vmcnt(4)
L_gt96:
    s_xor_b32 s46, s43, 131072
    buffer_load_dwordx4 v[96:99], v2, s[24:27], s46 offen offset:0 nt
    v_mfma_f32_16x16x32_bf16 v[16:19], v[104:107], v[20:23], v[16:19]
    v_fma_f32 v85, v85, s45, -v28
    v_exp_f32 v85, v85
    s_nop 0
    v_add_f32 v30, v30, v85
    v_cvt_pk_bf16_f32 v85, v85, v85
    v_and_b32_dpp v24, v77, v12 row_shl:4 row_mask:0xf bank_mask:0xf bound_ctrl:0
    v_and_b32_dpp v25, v77, v13 row_shl:4 row_mask:0xf bank_mask:0xf bound_ctrl:0
    v_and_b32 v26, v77, v14
    v_and_b32 v27, v77, v15
    s_waitcnt vmcnt(5)
    s_cbranch_vccnz L_gt97
    s_waitcnt vmcnt(4)
L_gt97:
    buffer_load_dwordx4 v[100:103], v2, s[24:27], s46 offen offset:1024 nt
    v_mfma_f32_16x16x32_bf16 v[16:19], v[108:111], v[24:27], v[16:19]
    s_waitcnt lgkmcnt(0)
    v_cmp_ne_u32 vcc, 0, v60
    ds_read_b32 v60, v39 offset:5704
    v_fma_f32 v86, v86, s45, -v28
    v_exp_f32 v86, v86
    s_nop 0
    v_add_f32 v30, v30, v86
    v_cvt_pk_bf16_f32 v86, v86, v86
    v_and_b32 v20, v78, v12
    v_and_b32 v21, v78, v13
    v_and_b32_dpp v22, v78, v14 row_shr:4 row_mask:0xf bank_mask:0xf bound_ctrl:0
    v_and_b32_dpp v23, v78, v15 row_shr:4 row_mask:0xf bank_mask:0xf bound_ctrl:0
    s_waitcnt vmcnt(5)
    s_cbranch_vccnz L_gt98
    s_waitcnt vmcnt(4)
L_gt98:
    buffer_load_dwordx4 v[104:107], v2, s[24:27], s46 offen offset:2048 nt
    v_mfma_f32_16x16x32_bf16 v[16:19], v[112:115], v[20:23], v[16:19]
    s_mov_b64 exec, 1
    ds_add_u32 v39, v61 offset:5700
    s_mov_b64 exec, -1
    v_fma_f32 v87, v87, s45, -v28
    v_exp_f32 v87, v87
    s_nop 0
    v_add_f32 v30, v30, v87
    v_cvt_pk_bf16_f32 v87, v87, v87
    v_and_b32_dpp v24, v78, v12 row_shl:4 row_mask:0xf bank_mask:0xf bound_ctrl:0
    v_and_b32_dpp v25, v78, v13 row_shl:4 row_mask:0xf bank_mask:0xf bound_ctrl:0
    v_and_b32 v26, v78, v14
    v_and_b32 v27, v78, v15
    s_waitcnt vmcnt(5)
    s_cbranch_vccnz L_gt99
    s_waitcnt vmcnt(4)
L_gt99:
    buffer_load_dwordx4 v[108:111], v2, s[24:27], s46 offen offset:3072 nt
    v_mfma_f32_16x16x32_bf16 v[16:19], v[116:119], v[24:27], v[16:19]
    s_waitcnt lgkmcnt(0)
    v_cmp_ne_u32 vcc, 0, v60
    ds_read_b32 v60, v39 offset:5704
    v_fma_f32 v88, v88, s45, -v28
    v_exp_f32 v88, v88
    s_nop 0
    v_add_f32 v30, v30, v88
    v_cvt_pk_bf16_f32 v88, v88, v88
    v_and_b32 v20, v79, v12
    v_and_b32 v21, v79, v13
    v_and_b32_dpp v22, v79, v14 row_shr:4 row_mask:0xf bank_mask:0xf bound_ctrl:0
    v_and_b32_dpp v23, v79, v15 row_shr:4 row_mask:0xf bank_mask:0xf bound_ctrl:0
    s_waitcnt vmcnt(5)
    s_cbranch_vccnz L_gt100
    s_waitcnt vmcnt(4)
L_gt100:
    s_xor_b32 s46, s43, 147456
    buffer_load_dwordx4 v[112:115], v2, s[24:27], s46 offen offset:0 nt
    v_mfma_f32_16x16x32_bf16 v[16:19], v[120:123], v[20:23], v[16:19]
    v_fma_f32 v89, v89, s45, -v28
    v_exp_f32 v89, v89
    s_nop 0
    v_add_f32 v30, v30, v89
    v_cvt_pk_bf16_f32 v89, v89, v89
    v_and_b32_dpp v24, v79, v12 row_shl:4 row_mask:0xf bank_mask:0xf bound_ctrl:0
    v_and_b32_dpp v25, v79, v13 row_shl:4 row_mask:0xf bank_mask:0xf bound_ctrl:0
    v_and_b32 v26, v79, v14
    v_and_b32 v27, v79, v15
    s_waitcnt vmcnt(5)
    s_cbranch_vccnz L_gt101
    s_waitcnt vmcnt(4)
L_gt101:
    buffer_load_dwordx4 v[116:119], v2, s[24:27], s46 offen offset:1024 nt
    v_mfma_f32_16x16x32_bf16 v[16:19], v[124:127], v[24:27], v[16:19]
    s_waitcnt lgkmcnt(0)
    v_cmp_ne_u32 vcc, 0, v60
    ds_read_b32 v60, v39 offset:5704
    v_fma_f32 v90, v90, s45, -v28
    v_exp_f32 v90, v90
    s_nop 0
    v_add_f32 v30, v30, v90
    v_cvt_pk_bf16_f32 v90, v90, v90
    v_and_b32 v20, v80, v12
    v_and_b32 v21, v80, v13
    v_and_b32_dpp v22, v80, v14 row_shr:4 row_mask:0xf bank_mask:0xf bound_ctrl:0
    v_and_b32_dpp v23, v80, v15 row_shr:4 row_mask:0xf bank_mask:0xf bound_ctrl:0
    s_waitcnt vmcnt(5)
    s_cbranch_vccnz L_gt102
    s_waitcnt vmcnt(4)
L_gt102:
    buffer_load_dwordx4 v[120:123], v2, s[24:27], s46 offen offset:2048 nt
    v_mfma_f32_16x16x32_bf16 v[16:19], v[96:99], v[20:23], v[16:19]
    s_mov_b64 exec, 1
    ds_add_u32 v39, v61 offset:5700
    s_mov_b64 exec, -1
    v_fma_f32 v91, v91, s45, -v28
    v_exp_f32 v91, v91
    s_nop 0
    v_add_f32 v30, v30, v91
    v_cvt_pk_bf16_f32 v91, v91, v91
    v_and_b32_dpp v24, v80, v12 row_shl:4 row_mask:0xf bank_mask:0xf bound_ctrl:0
    v_and_b32_dpp v25, v80, v13 row_shl:4 row_mask:0xf bank_mask:0xf bound_ctrl:0
    v_and_b32 v26, v80, v14
    v_and_b32 v27, v80, v15
    s_waitcnt vmcnt(5)
    s_cbranch_vccnz L_gt103
    s_waitcnt vmcnt(4)
L_gt103:
    buffer_load_dwordx4 v[124:127], v2, s[24:27], s46 offen offset:3072 nt
    v_mfma_f32_16x16x32_bf16 v[16:19], v[100:103], v[24:27], v[16:19]
    s_waitcnt lgkmcnt(0)
    v_cmp_ne_u32 vcc, 0, v60
    ds_read_b32 v60, v39 offset:5704
    v_fma_f32 v92, v92, s45, -v28
    v_exp_f32 v92, v92
    s_nop 0
    v_add_f32 v30, v30, v92
    v_cvt_pk_bf16_f32 v92, v92, v92
    v_and_b32 v20, v81, v12
    v_and_b32 v21, v81, v13
    v_and_b32_dpp v22, v81, v14 row_shr:4 row_mask:0xf bank_mask:0xf bound_ctrl:0
    v_and_b32_dpp v23, v81, v15 row_shr:4 row_mask:0xf bank_mask:0xf bound_ctrl:0
    s_waitcnt vmcnt(5)
    s_cbranch_vccnz L_gt104
    s_waitcnt vmcnt(4)
L_gt104:
    s_xor_b32 s46, s43, 163840
    buffer_load_dwordx4 v[96:99], v2, s[24:27], s46 offen offset:0 nt
    v_mfma_f32_16x16x32_bf16 v[16:19], v[104:107], v[20:23], v[16:19]
    v_fma_f32 v93, v93, s45, -v28
    v_exp_f32 v93, v93
    s_nop 0
    v_add_f32 v30, v30, v93
    v_cvt_pk_bf16_f32 v93, v93, v93
    v_and_b32_dpp v24, v81, v12 row_shl:4 row_mask:0xf bank_mask:0xf bound_ctrl:0
    v_and_b32_dpp v25, v81, v13 row_shl:4 row_mask:0xf bank_mask:0xf bound_ctrl:0
    v_and_b32 v26, v81, v14
    v_and_b32 v27, v81, v15
    s_waitcnt vmcnt(5)
    s_cbranch_vccnz L_gt105
    s_waitcnt vmcnt(4)
L_gt105:
    buffer_load_dwordx4 v[100:103], v2, s[24:27], s46 offen offset:1024 nt
    v_mfma_f32_16x16x32_bf16 v[16:19], v[108:111], v[24:27], v[16:19]
    s_waitcnt lgkmcnt(0)
    v_cmp_ne_u32 vcc, 0, v60
    ds_read_b32 v60, v39 offset:5704
    v_fma_f32 v94, v94, s45, -v28
    v_exp_f32 v94, v94
    s_nop 0
    v_add_f32 v30, v30, v94
    v_cvt_pk_bf16_f32 v94, v94, v94
    v_and_b32 v20, v82, v12
    v_and_b32 v21, v82, v13
    v_and_b32_dpp v22, v82, v14 row_shr:4 row_mask:0xf bank_mask:0xf bound_ctrl:0
    v_and_b32_dpp v23, v82, v15 row_shr:4 row_mask:0xf bank_mask:0xf bound_ctrl:0
    s_waitcnt vmcnt(5)
    s_cbranch_vccnz L_gt106
    s_waitcnt vmcnt(4)
L_gt106:
    buffer_load_dwordx4 v[104:107], v2, s[24:27], s46 offen offset:2048 nt
    v_mfma_f32_16x16x32_bf16 v[16:19], v[112:115], v[20:23], v[16:19]
    s_mov_b64 exec, 1
    ds_add_u32 v39, v61 offset:5700
    s_mov_b64 exec, -1
    v_fma_f32 v95, v95, s45, -v28
    v_exp_f32 v95, v95
    s_nop 0
    v_add_f32 v30, v30, v95
    v_cvt_pk_bf16_f32 v95, v95, v95
    s_nop 1
    v_add_f32_dpp v29, v30, v30 row_half_mirror row_mask:0xf bank_mask:0xf
    v_mov_b32 v3, v29
    s_nop 1
    v_permlane16_swap_b32 v29, v3
    v_add_f32 v29, v29, v3
    v_mov_b32 v3, v29
    s_nop 1
    v_permlane32_swap_b32 v29, v3
    v_add_f32 v29, v29, v3
    s_mov_b64 exec, 0x101
    ds_write_b64 v35, v[28:29] offset:5632
    s_mov_b64 exec, 1
    ds_add_u32 v39, v61 offset:5708
    s_mov_b64 exec, -1
    v_and_b32_dpp v24, v82, v12 row_shl:4 row_mask:0xf bank_mask:0xf bound_ctrl:0
    v_and_b32_dpp v25, v82, v13 row_shl:4 row_mask:0xf bank_mask:0xf bound_ctrl:0
    v_and_b32 v26, v82, v14
    v_and_b32 v27, v82, v15
    s_waitcnt vmcnt(5)
    s_cbranch_vccnz L_gt107
    s_waitcnt vmcnt(4)
L_gt107:
    buffer_load_dwordx4 v[108:111], v2, s[24:27], s46 offen offset:3072 nt
    v_mfma_f32_16x16x32_bf16 v[16:19], v[116:119], v[24:27], v[16:19]
    s_waitcnt lgkmcnt(0)
    v_cmp_ne_u32 vcc, 0, v60
    ds_read_b32 v60, v39 offset:5704
    v_and_b32 v20, v83, v12
    v_and_b32 v21, v83, v13
    v_and_b32_dpp v22, v83, v14 row_shr:4 row_mask:0xf bank_mask:0xf bound_ctrl:0
    v_and_b32_dpp v23, v83, v15 row_shr:4 row_mask:0xf bank_mask:0xf bound_ctrl:0
    s_waitcnt vmcnt(5)
    s_cbranch_vccnz L_gt108
    s_waitcnt vmcnt(4)
L_gt108:
    s_xor_b32 s46, s43, 180224
    buffer_load_dwordx4 v[112:115], v2, s[24:27], s46 offen offset:0 nt
    v_mfma_f32_16x16x32_bf16 v[16:19], v[120:123], v[20:23], v[16:19]
    v_and_b32_dpp v24, v83, v12 row_shl:4 row_mask:0xf bank_mask:0xf bound_ctrl:0
    v_and_b32_dpp v25, v83, v13 row_shl:4 row_mask:0xf bank_mask:0xf bound_ctrl:0
    v_and_b32 v26, v83, v14
    v_and_b32 v27, v83, v15
    s_waitcnt vmcnt(5)
    s_cbranch_vccnz L_gt109
    s_waitcnt vmcnt(4)
L_gt109:
    buffer_load_dwordx4 v[116:119], v2, s[24:27], s46 offen offset:1024 nt
    v_mfma_f32_16x16x32_bf16 v[16:19], v[124:127], v[24:27], v[16:19]
    s_waitcnt lgkmcnt(0)
    v_cmp_ne_u32 vcc, 0, v60
    ds_read_b32 v60, v39 offset:5704
    v_and_b32 v20, v84, v12
    v_and_b32 v21, v84, v13
    v_and_b32_dpp v22, v84, v14 row_shr:4 row_mask:0xf bank_mask:0xf bound_ctrl:0
    v_and_b32_dpp v23, v84, v15 row_shr:4 row_mask:0xf bank_mask:0xf bound_ctrl:0
    s_waitcnt vmcnt(5)
    s_cbranch_vccnz L_gt110
    s_waitcnt vmcnt(4)
L_gt110:
    buffer_load_dwordx4 v[120:123], v2, s[24:27], s46 offen offset:2048 nt
    v_mfma_f32_16x16x32_bf16 v[16:19], v[96:99], v[20:23], v[16:19]
    s_mov_b64 exec, 1
    ds_add_u32 v39, v61 offset:5700
    s_mov_b64 exec, -1
    v_and_b32_dpp v24, v84, v12 row_shl:4 row_mask:0xf bank_mask:0xf bound_ctrl:0
    v_and_b32_dpp v25, v84, v13 row_shl:4 row_mask:0xf bank_mask:0xf bound_ctrl:0
    v_and_b32 v26, v84, v14
    v_and_b32 v27, v84, v15
    s_waitcnt vmcnt(5)
    s_cbranch_vccnz L_gt111
    s_waitcnt vmcnt(4)
L_gt111:
    buffer_load_dwordx4 v[124:127], v2, s[24:27], s46 offen offset:3072 nt
    v_mfma_f32_16x16x32_bf16 v[16:19], v[100:103], v[24:27], v[16:19]
    s_waitcnt lgkmcnt(0)
    v_cmp_ne_u32 vcc, 0, v60
    ds_read_b32 v60, v39 offset:5704
    v_and_b32 v20, v85, v12
    v_and_b32 v21, v85, v13
    v_and_b32_dpp v22, v85, v14 row_shr:4 row_mask:0xf bank_mask:0xf bound_ctrl:0
    v_and_b32_dpp v23, v85, v15 row_shr:4 row_mask:0xf bank_mask:0xf bound_ctrl:0
    s_waitcnt vmcnt(5)
    s_cbranch_vccnz L_gt112
    s_waitcnt vmcnt(4)
L_gt112:
    s_xor_b32 s46, s43, 196608
    buffer_load_dwordx4 v[96:99], v2, s[24:27], s46 offen offset:0 nt
    v_mfma_f32_16x16x32_bf16 v[16:19], v[104:107], v[20:23], v[16:19]
    v_and_b32_dpp v24, v85, v12 row_shl:4 row_mask:0xf bank_mask:0xf bound_ctrl:0
    v_and_b32_dpp v25, v85, v13 row_shl:4 row_mask:0xf bank_mask:0xf bound_ctrl:0
    v_and_b32 v26, v85, v14
    v_and_b32 v27, v85, v15
    s_waitcnt vmcnt(5)
    s_cbranch_vccnz L_gt113
    s_waitcnt vmcnt(4)
L_gt113:
    buffer_load_dwordx4 v[100:103], v2, s[24:27], s46 offen offset:1024 nt
    v_mfma_f32_16x16x32_bf16 v[16:19], v[108:111], v[24:27], v[16:19]
    s_waitcnt lgkmcnt(0)
    v_cmp_ne_u32 vcc, 0, v60
    ds_read_b32 v60, v39 offset:5704
    v_and_b32 v20, v86, v12
    v_and_b32 v21, v86, v13
    v_and_b32_dpp v22, v86, v14 row_shr:4 row_mask:0xf bank_mask:0xf bound_ctrl:0
    v_and_b32_dpp v23, v86, v15 row_shr:4 row_mask:0xf bank_mask:0xf bound_ctrl:0
    s_waitcnt vmcnt(5)
    s_cbranch_vccnz L_gt114
    s_waitcnt vmcnt(4)
L_gt114:
    buffer_load_dwordx4 v[104:107], v2, s[24:27], s46 offen offset:2048 nt
    v_mfma_f32_16x16x32_bf16 v[16:19], v[112:115], v[20:23], v[16:19]
    s_mov_b64 exec, 1
    ds_add_u32 v39, v61 offset:5700
    s_mov_b64 exec, -1
    v_and_b32_dpp v24, v86, v12 row_shl:4 row_mask:0xf bank_mask:0xf bound_ctrl:0
    v_and_b32_dpp v25, v86, v13 row_shl:4 row_mask:0xf bank_mask:0xf bound_ctrl:0
    v_and_b32 v26, v86, v14
    v_and_b32 v27, v86, v15
    s_waitcnt vmcnt(5)
    s_cbranch_vccnz L_gt115
    s_waitcnt vmcnt(4)
L_gt115:
    buffer_load_dwordx4 v[108:111], v2, s[24:27], s46 offen offset:3072 nt
    v_mfma_f32_16x16x32_bf16 v[16:19], v[116:119], v[24:27], v[16:19]
    s_waitcnt lgkmcnt(0)
    v_cmp_ne_u32 vcc, 0, v60
    ds_read_b32 v60, v39 offset:5704
    v_and_b32 v20, v87, v12
    v_and_b32 v21, v87, v13
    v_and_b32_dpp v22, v87, v14 row_shr:4 row_mask:0xf bank_mask:0xf bound_ctrl:0
    v_and_b32_dpp v23, v87, v15 row_shr:4 row_mask:0xf bank_mask:0xf bound_ctrl:0
    s_waitcnt vmcnt(5)
    s_cbranch_vccnz L_gt116
    s_waitcnt vmcnt(4)
L_gt116:
    s_xor_b32 s46, s43, 212992
    buffer_load_dwordx4 v[112:115], v2, s[24:27], s46 offen offset:0 nt
    v_mfma_f32_16x16x32_bf16 v[16:19], v[120:123], v[20:23], v[16:19]
    v_and_b32_dpp v24, v87, v12 row_shl:4 row_mask:0xf bank_mask:0xf bound_ctrl:0
    v_and_b32_dpp v25, v87, v13 row_shl:4 row_mask:0xf bank_mask:0xf bound_ctrl:0
    v_and_b32 v26, v87, v14
    v_and_b32 v27, v87, v15
    s_waitcnt vmcnt(5)
    s_cbranch_vccnz L_gt117
    s_waitcnt vmcnt(4)
L_gt117:
    buffer_load_dwordx4 v[116:119], v2, s[24:27], s46 offen offset:1024 nt
    v_mfma_f32_16x16x32_bf16 v[16:19], v[124:127], v[24:27], v[16:19]
    s_waitcnt lgkmcnt(0)
    v_cmp_ne_u32 vcc, 0, v60
    ds_read_b32 v60, v39 offset:5704
    v_and_b32 v20, v88, v12
    v_and_b32 v21, v88, v13
    v_and_b32_dpp v22, v88, v14 row_shr:4 row_mask:0xf bank_mask:0xf bound_ctrl:0
    v_and_b32_dpp v23, v88, v15 row_shr:4 row_mask:0xf bank_mask:0xf bound_ctrl:0
    s_waitcnt vmcnt(5)
    s_cbranch_vccnz L_gt118
    s_waitcnt vmcnt(4)
L_gt118:
    buffer_load_dwordx4 v[120:123], v2, s[24:27], s46 offen offset:2048 nt
    v_mfma_f32_16x16x32_bf16 v[16:19], v[96:99], v[20:23], v[16:19]
    s_mov_b64 exec, 1
    ds_add_u32 v39, v61 offset:5700
    s_mov_b64 exec, -1
    v_and_b32_dpp v24, v88, v12 row_shl:4 row_mask:0xf bank_mask:0xf bound_ctrl:0
    v_and_b32_dpp v25, v88, v13 row_shl:4 row_mask:0xf bank_mask:0xf bound_ctrl:0
    v_and_b32 v26, v88, v14
    v_and_b32 v27, v88, v15
    s_waitcnt vmcnt(5)
    s_cbranch_vccnz L_gt119
    s_waitcnt vmcnt(4)
L_gt119:
    buffer_load_dwordx4 v[124:127], v2, s[24:27], s46 offen offset:3072 nt
    v_mfma_f32_16x16x32_bf16 v[16:19], v[100:103], v[24:27], v[16:19]
    s_waitcnt lgkmcnt(0)
    v_cmp_ne_u32 vcc, 0, v60
    ds_read_b32 v60, v39 offset:5704
    v_and_b32 v20, v89, v12
    v_and_b32 v21, v89, v13
    v_and_b32_dpp v22, v89, v14 row_shr:4 row_mask:0xf bank_mask:0xf bound_ctrl:0
    v_and_b32_dpp v23, v89, v15 row_shr:4 row_mask:0xf bank_mask:0xf bound_ctrl:0
    s_waitcnt vmcnt(5)
    s_cbranch_vccnz L_gt120
    s_waitcnt vmcnt(4)
L_gt120:
    s_xor_b32 s46, s43, 229376
    buffer_load_dwordx4 v[96:99], v2, s[24:27], s46 offen offset:0 nt
    v_mfma_f32_16x16x32_bf16 v[16:19], v[104:107], v[20:23], v[16:19]
    v_and_b32_dpp v24, v89, v12 row_shl:4 row_mask:0xf bank_mask:0xf bound_ctrl:0
    v_and_b32_dpp v25, v89, v13 row_shl:4 row_mask:0xf bank_mask:0xf bound_ctrl:0
    v_and_b32 v26, v89, v14
    v_and_b32 v27, v89, v15
    s_waitcnt vmcnt(5)
    s_cbranch_vccnz L_gt121
    s_waitcnt vmcnt(4)
L_gt121:
    buffer_load_dwordx4 v[100:103], v2, s[24:27], s46 offen offset:1024 nt
    v_mfma_f32_16x16x32_bf16 v[16:19], v[108:111], v[24:27], v[16:19]
    s_waitcnt lgkmcnt(0)
    v_cmp_ne_u32 vcc, 0, v60
    ds_read_b32 v60, v39 offset:5704
    v_and_b32 v20, v90, v12
    v_and_b32 v21, v90, v13
    v_and_b32_dpp v22, v90, v14 row_shr:4 row_mask:0xf bank_mask:0xf bound_ctrl:0
    v_and_b32_dpp v23, v90, v15 row_shr:4 row_mask:0xf bank_mask:0xf bound_ctrl:0
    s_waitcnt vmcnt(5)
    s_cbranch_vccnz L_gt122
    s_waitcnt vmcnt(4)
L_gt122:
    buffer_load_dwordx4 v[104:107], v2, s[24:27], s46 offen offset:2048 nt
    v_mfma_f32_16x16x32_bf16 v[16:19], v[112:115], v[20:23], v[16:19]
    v_and_b32_dpp v24, v90, v12 row_shl:4 row_mask:0xf bank_mask:0xf bound_ctrl:0
    v_and_b32_dpp v25, v90, v13 row_shl:4 row_mask:0xf bank_mask:0xf bound_ctrl:0
    v_and_b32 v26, v90, v14
    v_and_b32 v27, v90, v15
    s_waitcnt vmcnt(5)
    s_cbranch_vccnz L_gt123
    s_waitcnt vmcnt(4)
L_gt123:
    buffer_load_dwordx4 v[108:111], v2, s[24:27], s46 offen offset:3072 nt
    v_mfma_f32_16x16x32_bf16 v[16:19], v[116:119], v[24:27], v[16:19]
    s_waitcnt lgkmcnt(0)
    v_cmp_ne_u32 vcc, 0, v60
    ds_read_b32 v60, v39 offset:5704
    v_and_b32 v20, v91, v12
    v_and_b32 v21, v91, v13
    v_and_b32_dpp v22, v91, v14 row_shr:4 row_mask:0xf bank_mask:0xf bound_ctrl:0
    v_and_b32_dpp v23, v91, v15 row_shr:4 row_mask:0xf bank_mask:0xf bound_ctrl:0
    s_waitcnt vmcnt(5)
    s_cbranch_vccnz L_gt124
    s_waitcnt vmcnt(4)
L_gt124:
    s_xor_b32 s46, s43, 245760
    buffer_load_dwordx4 v[112:115], v2, s[24:27], s46 offen offset:0 nt
    v_mfma_f32_16x16x32_bf16 v[16:19], v[120:123], v[20:23], v[16:19]
    v_and_b32_dpp v24, v91, v12 row_shl:4 row_mask:0xf bank_mask:0xf bound_ctrl:0
    v_and_b32_dpp v25, v91, v13 row_shl:4 row_mask:0xf bank_mask:0xf bound_ctrl:0
    v_and_b32 v26, v91, v14
    v_and_b32 v27, v91, v15
    s_waitcnt vmcnt(5)
    s_cbranch_vccnz L_gt125
    s_waitcnt vmcnt(4)
L_gt125:
    buffer_load_dwordx4 v[116:119], v2, s[24:27], s46 offen offset:1024 nt
    v_mfma_f32_16x16x32_bf16 v[16:19], v[124:127], v[24:27], v[16:19]
    s_waitcnt lgkmcnt(0)
    v_cmp_ne_u32 vcc, 0, v60
    ds_read_b32 v60, v39 offset:5704
    v_and_b32 v20, v92, v12
    v_and_b32 v21, v92, v13
    v_and_b32_dpp v22, v92, v14 row_shr:4 row_mask:0xf bank_mask:0xf bound_ctrl:0
    v_and_b32_dpp v23, v92, v15 row_shr:4 row_mask:0xf bank_mask:0xf bound_ctrl:0
    s_waitcnt vmcnt(5)
    s_cbranch_vccnz L_gt126
    s_waitcnt vmcnt(4)
L_gt126:
    buffer_load_dwordx4 v[120:123], v2, s[24:27], s46 offen offset:2048 nt
    v_mfma_f32_16x16x32_bf16 v[16:19], v[96:99], v[20:23], v[16:19]
    v_and_b32_dpp v24, v92, v12 row_shl:4 row_mask:0xf bank_mask:0xf bound_ctrl:0
    v_and_b32_dpp v25, v92, v13 row_shl:4 row_mask:0xf bank_mask:0xf bound_ctrl:0
    v_and_b32 v26, v92, v14
    v_and_b32 v27, v92, v15
    s_waitcnt vmcnt(5)
    s_cbranch_vccnz L_gt127
    s_waitcnt vmcnt(4)
L_gt127:
    buffer_load_dwordx4 v[124:127], v2, s[24:27], s46 offen offset:3072 nt
    v_mfma_f32_16x16x32_bf16 v[16:19], v[100:103], v[24:27], v[16:19]
    ds_read_b32 v62, v39 offset:5696
    ds_read_b32 v63, v37 offset:5824
    v_and_b32 v20, v93, v12
    v_and_b32 v21, v93, v13
    v_and_b32_dpp v22, v93, v14 row_shr:4 row_mask:0xf bank_mask:0xf bound_ctrl:0
    v_and_b32_dpp v23, v93, v15 row_shr:4 row_mask:0xf bank_mask:0xf bound_ctrl:0
    s_waitcnt vmcnt(5)
    s_nop 0
    v_mfma_f32_16x16x32_bf16 v[16:19], v[104:107], v[20:23], v[16:19]
    v_and_b32_dpp v24, v93, v12 row_shl:4 row_mask:0xf bank_mask:0xf bound_ctrl:0
    v_and_b32_dpp v25, v93, v13 row_shl:4 row_mask:0xf bank_mask:0xf bound_ctrl:0
    v_and_b32 v26, v93, v14
    v_and_b32 v27, v93, v15
    s_waitcnt vmcnt(4)
    s_nop 0
    v_mfma_f32_16x16x32_bf16 v[16:19], v[108:111], v[24:27], v[16:19]
    v_and_b32 v20, v94, v12
    v_and_b32 v21, v94, v13
    v_and_b32_dpp v22, v94, v14 row_shr:4 row_mask:0xf bank_mask:0xf bound_ctrl:0
    v_and_b32_dpp v23, v94, v15 row_shr:4 row_mask:0xf bank_mask:0xf bound_ctrl:0
    s_waitcnt vmcnt(3)
    s_nop 0
    v_mfma_f32_16x16x32_bf16 v[16:19], v[112:115], v[20:23], v[16:19]
    v_and_b32_dpp v24, v94, v12 row_shl:4 row_mask:0xf bank_mask:0xf bound_ctrl:0
    v_and_b32_dpp v25, v94, v13 row_shl:4 row_mask:0xf bank_mask:0xf bound_ctrl:0
    v_and_b32 v26, v94, v14
    v_and_b32 v27, v94, v15
    s_waitcnt vmcnt(2)
    s_nop 0
    v_mfma_f32_16x16x32_bf16 v[16:19], v[116:119], v[24:27], v[16:19]
    v_and_b32 v20, v95, v12
    v_and_b32 v21, v95, v13
    v_and_b32_dpp v22, v95, v14 row_shr:4 row_mask:0xf bank_mask:0xf bound_ctrl:0
    v_and_b32_dpp v23, v95, v15 row_shr:4 row_mask:0xf bank_mask:0xf bound_ctrl:0
    s_waitcnt vmcnt(1)
    s_nop 0
    v_mfma_f32_16x16x32_bf16 v[16:19], v[120:123], v[20:23], v[16:19]
    v_and_b32_dpp v24, v95, v12 row_shl:4 row_mask:0xf bank_mask:0xf bound_ctrl:0
    v_and_b32_dpp v25, v95, v13 row_shl:4 row_mask:0xf bank_mask:0xf bound_ctrl:0
    v_and_b32 v26, v95, v14
    v_and_b32 v27, v95, v15
    s_waitcnt vmcnt(0)
    s_nop 0
    v_mfma_f32_16x16x32_bf16 v[16:19], v[124:127], v[24:27], v[16:19]
    s_cmp_eq_u32 s42, 0
    s_waitcnt lgkmcnt(0)
    v_readfirstlane_b32 s4, v62
    s_nop 4
    ds_write2_b32 v34, v16, v17 offset0:0 offset1:8
    ds_write2_b32 v34, v18, v19 offset0:16 offset1:24
    s_cbranch_scc1 L_cons
    s_cmp_eq_u32 s4, s49
    s_waitcnt lgkmcnt(0)
    s_barrier
    ds_read_b32 v64, v36 offset:0
    ds_read_b32 v65, v36 offset:1408
    ds_read_b32 v66, v36 offset:2816
    ds_read_b32 v67, v36 offset:4224
    s_cbranch_scc0 L_far
    s_waitcnt lgkmcnt(2)
    v_add_f32 v64, v64, v65
    s_waitcnt lgkmcnt(0)
    v_add_f32 v66, v66, v67
    v_add_f32 v64, v64, v66
    v_bfi_b32 v64, 1, v63, v64
    buffer_store_dword v64, v37, s[36:39], s47 offen
    s_endpgm
L_far:
    ds_read_b32 v62, v39 offset:5696
    ds_read_b32 v63, v37 offset:5824
    s_waitcnt lgkmcnt(0)
    s_waitcnt lgkmcnt(2)
    v_add_f32 v64, v64, v65
    s_waitcnt lgkmcnt(0)
    v_add_f32 v66, v66, v67
    v_add_f32 v64, v64, v66
    v_bfi_b32 v64, 1, v63, v64
    buffer_store_dword v64, v37, s[36:39], s47 offen sc1
    s_endpgm
L_cons:
    v_mov_b32 v3, s54
    s_waitcnt lgkmcnt(0)
    s_barrier
    s_mov_b32 exec_lo, 0xffffff00
    buffer_load_dwordx2 v[44:45], v41, s[36:39], s47 offen offset:0 sc1
    buffer_load_dwordx2 v[46:47], v41, s[36:39], s47 offen offset:64 sc1
    buffer_load_dwordx2 v[48:49], v41, s[36:39], s47 offen offset:128 sc1
    buffer_load_dwordx2 v[50:51], v41, s[36:39], s47 offen offset:192 sc1
    ds_read_b64 v[64:65], v38 offset:5824
    ds_read_b64 v[66:67], v38 offset:6336
    ds_read_b64 v[68:69], v38 offset:6848
    ds_read_b64 v[70:71], v38 offset:7360
    s_mov_b32 exec_lo, -1
    ds_read_b32 v72, v42 offset:5760
    ds_read_b32 v73, v3 offset:5760
    s_mov_b32 exec_hi, 0
    ds_read_b64 v[52:53], v40 offset:0
    ds_read_b64 v[54:55], v40 offset:64
    ds_read_b64 v[56:57], v40 offset:160
    ds_read_b64 v[58:59], v40 offset:224
    s_mov_b32 s4, 0x00ff00ff
    s_mov_b32 s5, 0x00ff00ff
    s_waitcnt lgkmcnt(0)
    v_pk_mul_f32 v[52:53], v[52:53], v[72:73] op_sel:[0,1] op_sel_hi:[1,1]
    v_pk_mul_f32 v[54:55], v[54:55], v[72:73] op_sel:[0,1] op_sel_hi:[1,1]
    v_pk_mul_f32 v[56:57], v[56:57], v[72:73] op_sel:[0,1] op_sel_hi:[1,1]
    v_pk_mul_f32 v[58:59], v[58:59], v[72:73] op_sel:[0,1] op_sel_hi:[1,1]
    s_mov_b32 exec_lo, 0xffffff00
    s_mov_b32 exec_hi, -1
L_poll:
    s_waitcnt vmcnt(3)
    v_xor_b32 v44, v44, v64
    v_xor_b32 v45, v45, v65
    v_or_b32 v3, v44, v45
    s_waitcnt vmcnt(2)
    v_xor_b32 v46, v46, v66
    v_xor_b32 v47, v47, v67
    v_or3_b32 v3, v46, v47, v3
    s_waitcnt vmcnt(1)
    v_xor_b32 v48, v48, v68
    v_xor_b32 v49, v49, v69
    v_or3_b32 v3, v48, v49, v3
    s_waitcnt vmcnt(0)
    v_xor_b32 v50, v50, v70
    v_xor_b32 v51, v51, v71
    v_or3_b32 v3, v50, v51, v3
    v_and_b32 v3, 1, v3
    v_cmp_eq_u32 vcc, 1, v3
    s_sub_u32 s50, s50, 1
    s_cbranch_scc1 L_final
    s_cbranch_vccz L_final
    s_mov_b64 exec, vcc
    buffer_load_dwordx2 v[44:45], v41, s[36:39], s47 offen offset:0 sc1
    buffer_load_dwordx2 v[46:47], v41, s[36:39], s47 offen offset:64 sc1
    buffer_load_dwordx2 v[48:49], v41, s[36:39], s47 offen offset:128 sc1
    buffer_load_dwordx2 v[50:51], v41, s[36:39], s47 offen offset:192 sc1
    s_branch L_poll
L_final:
    s_mov_b64 exec, -1
    v_pk_fma_f32 v[44:45], v[44:45], v[72:73], v[52:53] op_sel_hi:[1,0,1]
    v_pk_fma_f32 v[48:49], v[48:49], v[72:73], v[56:57] op_sel_hi:[1,0,1]
    v_pk_fma_f32 v[46:47], v[46:47], v[72:73], v[54:55] op_sel_hi:[1,0,1]
    v_pk_fma_f32 v[50:51], v[50:51], v[72:73], v[58:59] op_sel_hi:[1,0,1]
    v_permlane32_swap_b32 v44, v48
    v_permlane32_swap_b32 v45, v49
    v_permlane32_swap_b32 v46, v50
    v_permlane32_swap_b32 v47, v51
    v_pk_add_f32 v[44:45], v[44:45], v[48:49]
    v_pk_add_f32 v[46:47], v[46:47], v[50:51]
    s_nop 1
    v_permlane16_swap_b32 v44, v46
    v_permlane16_swap_b32 v45, v47
    v_pk_add_f32 v[44:45], v[44:45], v[46:47]
    s_nop 1
    v_add_f32_dpp v44, v44, v44 row_ror:8 row_mask:0xf bank_mask:0xf
    v_add_f32_dpp v45, v45, v45 row_ror:8 row_mask:0xf bank_mask:0xf
    s_mov_b64 exec, s[4:5]
    v_cvt_pk_bf16_f32 v44, v44, v45
    buffer_store_dword v44, v43, s[28:31], s51 offen
    s_endpgm
L_helper:
    v_lshlrev_b32 v2, 4, v0
    s_mov_b32 s38, 1048576
    s_mov_b32 s39, 0x20000
    s_lshl_b32 s47, s41, 3
    s_add_u32 s47, s47, s42
    s_lshl_b32 s47, s47, 11
    s_getreg_b32 s49, hwreg(HW_REG_XCC_ID, 0, 4)
    s_or_b32 s49, s49, 0x100
    s_mov_b32 s50, 0x100000
    v_lshlrev_b32 v38, 3, v0
    v_and_b32 v30, 7, v0
    v_lshrrev_b32 v42, 3, v0
    v_lshlrev_b32 v41, 11, v42
    v_lshl_add_u32 v41, v30, 3, v41
    v_bfe_u32 v31, v0, 3, 1
    v_lshlrev_b32 v35, 5, v31
    s_mov_b32 s36, s14
    s_mov_b32 s37, s15
    s_mov_b32 s32, s12
    s_mov_b32 s33, s13
    s_mov_b32 s34, 256
    s_mov_b32 s35, 0x20000
    s_lshl_b32 s48, s41, 2
    s_and_b32 s55, s2, 7
    s_lshl_b32 s52, s55, 2
    s_lshl_b32 s55, s55, 9
    s_add_u32 s55, s55, 524288
    v_lshlrev_b32 v32, 2, v0
    v_lshlrev_b32 v68, 11, v30
    v_lshl_add_u32 v67, v31, 3, v68
    s_waitcnt vmcnt(0)
    s_cmp_eq_u32 s42, 0
    s_cbranch_scc1 L_hcons
    buffer_load_dwordx4 v[96:99], v2, s[36:39], s47 offen sc1
    s_mov_b64 exec, 0x101
    buffer_load_dwordx2 v[64:65], v67, s[36:39], s47 offen offset:1024 sc1
    buffer_load_dword v66, v68, s[36:39], s47 offen offset:1040 sc1
    s_mov_b64 exec, -1
    s_waitcnt vmcnt(0)
    v_not_b32 v96, v96
    v_not_b32 v97, v97
    v_not_b32 v98, v98
    v_not_b32 v99, v99
    v_not_b32 v64, v64
    v_not_b32 v65, v65
    v_not_b32 v66, v66
    ds_write_b128 v2, v[96:99] offset:5824
    s_mov_b64 exec, 1
L_hpoll:
    s_sleep 40
    buffer_load_dword v24, off, s[32:35], s48 sc1
    buffer_load_dword v25, off, s[32:35], s48 offset:128 sc1
    s_waitcnt vmcnt(0)
    v_or_b32 v24, v24, v25
    s_sub_u32 s50, s50, 8
    v_readfirstlane_b32 s56, v24
    s_cbranch_scc1 L_hst
    s_cmp_eq_u32 s56, 0
    s_cbranch_scc1 L_hpoll
L_hst:
    ds_write_b32 v39, v24 offset:5696
    s_cmp_lg_u32 s56, s49
    s_cbranch_scc1 L_hctl
    buffer_store_dword v66, off, s[36:39], s47 offset:1040
    s_branch L_hctl
L_hcons:
    buffer_load_dwordx2 v[96:97], v41, s[36:39], s47 offen offset:0 sc1
    buffer_load_dwordx2 v[98:99], v41, s[36:39], s47 offen offset:64 sc1
    buffer_load_dwordx2 v[100:101], v41, s[36:39], s47 offen offset:128 sc1
    buffer_load_dwordx2 v[102:103], v41, s[36:39], s47 offen offset:192 sc1
    buffer_load_dwordx2 v[104:105], v41, s[36:39], s47 offen offset:256 sc1
    buffer_load_dwordx2 v[106:107], v41, s[36:39], s47 offen offset:320 sc1
    buffer_load_dwordx2 v[108:109], v41, s[36:39], s47 offen offset:384 sc1
    buffer_load_dwordx2 v[110:111], v41, s[36:39], s47 offen offset:448 sc1
    buffer_load_dwordx2 v[112:113], v41, s[36:39], s47 offen offset:512 sc1
    buffer_load_dwordx2 v[114:115], v41, s[36:39], s47 offen offset:576 sc1
    buffer_load_dwordx2 v[116:117], v41, s[36:39], s47 offen offset:640 sc1
    buffer_load_dwordx2 v[118:119], v41, s[36:39], s47 offen offset:704 sc1
    buffer_load_dwordx2 v[120:121], v41, s[36:39], s47 offen offset:768 sc1
    buffer_load_dwordx2 v[122:123], v41, s[36:39], s47 offen offset:832 sc1
    buffer_load_dwordx2 v[124:125], v41, s[36:39], s47 offen offset:896 sc1
    buffer_load_dwordx2 v[126:127], v41, s[36:39], s47 offen offset:960 sc1
    buffer_load_dwordx2 v[64:65], v67, s[36:39], s47 offen offset:1024 sc1
    buffer_load_dword v66, v68, s[36:39], s47 offen offset:1040 sc1
    v_mov_b32 v24, s49
    s_cmp_ge_u32 s2, 8
    s_cbranch_scc1 L_hnl
    s_mov_b32 exec_hi, 0
    buffer_store_dword v39, v32, s[36:39], s55 offen
L_hnl:
    s_mov_b64 exec, 1
    s_waitcnt vmcnt(0)
    buffer_store_dword v24, off, s[32:35], s48
    s_mov_b64 exec, -1
    v_bfi_b32 v96, v96, 0, 1
    v_bfi_b32 v97, v97, 0, 1
    v_bfi_b32 v98, v98, 0, 1
    v_bfi_b32 v99, v99, 0, 1
    v_bfi_b32 v100, v100, 0, 1
    v_bfi_b32 v101, v101, 0, 1
    v_bfi_b32 v102, v102, 0, 1
    v_bfi_b32 v103, v103, 0, 1
    v_bfi_b32 v104, v104, 0, 1
    v_bfi_b32 v105, v105, 0, 1
    v_bfi_b32 v106, v106, 0, 1
    v_bfi_b32 v107, v107, 0, 1
    v_bfi_b32 v108, v108, 0, 1
    v_bfi_b32 v109, v109, 0, 1
    v_bfi_b32 v110, v110, 0, 1
    v_bfi_b32 v111, v111, 0, 1
    v_bfi_b32 v112, v112, 0, 1
    v_bfi_b32 v113, v113, 0, 1
    v_bfi_b32 v114, v114, 0, 1
    v_bfi_b32 v115, v115, 0, 1
    v_bfi_b32 v116, v116, 0, 1
    v_bfi_b32 v117, v117, 0, 1
    v_bfi_b32 v118, v118, 0, 1
    v_bfi_b32 v119, v119, 0, 1
    v_bfi_b32 v120, v120, 0, 1
    v_bfi_b32 v121, v121, 0, 1
    v_bfi_b32 v122, v122, 0, 1
    v_bfi_b32 v123, v123, 0, 1
    v_bfi_b32 v124, v124, 0, 1
    v_bfi_b32 v125, v125, 0, 1
    v_bfi_b32 v126, v126, 0, 1
    v_bfi_b32 v127, v127, 0, 1
    v_bfi_b32 v64, v64, 0, 1
    v_bfi_b32 v65, v65, 0, 1
    ds_write_b64 v38, v[96:97] offset:5824
    ds_write_b64 v38, v[98:99] offset:6336
    ds_write_b64 v38, v[100:101] offset:6848
    ds_write_b64 v38, v[102:103] offset:7360
    ds_write_b64 v38, v[104:105] offset:7872
    ds_write_b64 v38, v[106:107] offset:8384
    ds_write_b64 v38, v[108:109] offset:8896
    ds_write_b64 v38, v[110:111] offset:9408
    ds_write_b64 v38, v[112:113] offset:9920
    ds_write_b64 v38, v[114:115] offset:10432
    ds_write_b64 v38, v[116:117] offset:10944
    ds_write_b64 v38, v[118:119] offset:11456
    ds_write_b64 v38, v[120:121] offset:11968
    ds_write_b64 v38, v[122:123] offset:12480
    ds_write_b64 v38, v[124:125] offset:12992
    ds_write_b64 v38, v[126:127] offset:13504
    s_mov_b32 s7, 4
    s_mov_b64 exec, 0xfe
L_hack:
    s_sleep 40
    buffer_load_dword v20, v68, s[36:39], s47 offen offset:1040 sc1
    s_waitcnt vmcnt(0)
    v_cmp_eq_u32 vcc, v66, v20
    s_sub_u32 s7, s7, 1
    s_cbranch_vccz L_hctl
    s_cmp_lg_u32 s7, 0
    s_cbranch_scc1 L_hack
    s_mov_b64 exec, 1
    buffer_store_dword v24, off, s[32:35], s48 offset:128 sc1
L_hctl:
    s_mov_b64 exec, 1
    s_lshr_b32 s5, s2, 3
    s_lshl_b32 s5, s5, 2
    s_add_u32 s5, s5, s55
    s_bitcmp1_b32 s49, 0
    s_cselect_b32 s10, 17, 9
    s_cmp_eq_u32 s42, 0
    s_cselect_b32 s11, 5, 0
    s_add_u32 s11, s11, 88
    s_mov_b32 s7, 2
L_hlead:
    buffer_load_dword v24, off, s[32:35], s52 sc1
    s_waitcnt vmcnt(0)
    v_readfirstlane_b32 s6, v24
    s_cmp_eq_u32 s6, s49
    s_cbranch_scc1 L_hloop
    s_sub_u32 s7, s7, 1
    s_cbranch_scc0 L_hlead
    v_mov_b32 v20, 1
    ds_write_b32 v39, v20 offset:5704
    s_mov_b32 s11, 0
    s_branch L_hsum
L_hmore:
    s_cmp_eq_u32 s11, 0
    s_cbranch_scc1 L_hdone
    s_mov_b32 s11, 97
    s_mov_b64 exec, 1
L_hloop:
    ds_read_b32 v20, v39 offset:5700
    s_waitcnt lgkmcnt(0)
    buffer_store_dword v20, off, s[36:39], s5
    v_readfirstlane_b32 s6, v20
    s_cmp_ge_u32 s6, s11
    s_cbranch_scc1 L_hout
    s_mov_b32 exec_lo, -1
    buffer_load_dword v24, v32, s[36:39], s55 offen sc1
    s_waitcnt vmcnt(0)
    v_cmp_le_u32 vcc, s6, v24
    s_mov_b64 exec, 1
    s_bcnt1_i32_b32 s9, vcc_lo
    s_cmp_ge_u32 s9, s10
    s_cselect_b32 s9, 1, 0
    v_mov_b32 v20, s9
    ds_write_b32 v39, v20 offset:5704
    s_sleep 4
    s_branch L_hloop
L_hout:
    s_cmp_eq_u32 s11, 97
    s_cbranch_scc1 L_hdone
L_hsum:
    s_mov_b64 exec, 0xffff
L_hsum2:
    ds_read_b32 v33, v39 offset:5708
    ds_read_b128 v[72:75], v35 offset:5632
    ds_read_b128 v[76:79], v35 offset:5648
    s_waitcnt lgkmcnt(0)
    v_readfirstlane_b32 s4, v33
    s_cmp_eq_u32 s4, 8
    s_cbranch_scc1 L_hsum3
    s_sleep 4
    s_branch L_hsum2
L_hsum3:
    v_add_f32 v73, v73, v75
    v_add_f32 v77, v77, v79
    v_add_f32 v73, v73, v77
    s_cmp_eq_u32 s42, 0
    s_cbranch_scc1 L_hw
    v_bfi_b32 v72, 1, v64, v72
    v_bfi_b32 v73, 1, v65, v73
    s_mov_b64 exec, 0x101
    s_cmp_lg_u32 s56, s49
    s_cbranch_scc1 L_hfar
    buffer_store_dwordx2 v[72:73], v67, s[36:39], s47 offen offset:1024
    s_branch L_hmore
L_hfar:
    buffer_store_dwordx2 v[72:73], v67, s[36:39], s47 offen offset:1024 sc1
    s_branch L_hmore
L_hw:
    s_mov_b64 exec, 0xfefe
L_hw2:
    buffer_load_dwordx2 v[72:73], v67, s[36:39], s47 offen offset:1024 sc1
    s_waitcnt vmcnt(0)
    v_xor_b32 v72, v72, v64
    v_xor_b32 v73, v73, v65
    v_or_b32 v3, v72, v73
    v_and_b32 v3, 1, v3
    v_cmp_eq_u32 vcc, 1, v3
    s_sub_u32 s50, s50, 1
    s_cbranch_scc1 L_hw3
    s_cbranch_vccz L_hw3
    s_mov_b64 exec, vcc
    s_sleep 1
    s_branch L_hw2
L_hw3:
    s_mov_b64 exec, 0xffff
    s_nop 1
    v_max_f32_dpp v76, v72, v72 quad_perm:[1,0,3,2] row_mask:0xf bank_mask:0xf
    s_nop 1
    v_max_f32_dpp v76, v76, v76 quad_perm:[2,3,0,1] row_mask:0xf bank_mask:0xf
    s_nop 1
    v_max_f32_dpp v76, v76, v76 row_half_mirror row_mask:0xf bank_mask:0xf
    v_sub_f32 v72, v72, v76
    v_exp_f32 v72, v72
    s_nop 0
    v_mul_f32 v73, v73, v72
    s_nop 1
    v_add_f32_dpp v76, v73, v73 quad_perm:[1,0,3,2] row_mask:0xf bank_mask:0xf
    s_nop 1
    v_add_f32_dpp v76, v76, v76 quad_perm:[2,3,0,1] row_mask:0xf bank_mask:0xf
    s_nop 1
    v_add_f32_dpp v76, v76, v76 row_half_mirror row_mask:0xf bank_mask:0xf
    v_rcp_f32 v76, v76
    s_nop 0
    v_mul_f32 v72, v72, v76
    ds_write_b32 v32, v72 offset:5760
    s_branch L_hmore
L_hdone:
    s_waitcnt lgkmcnt(0)
L_fin:
L_end:
    s_endpgm
.fill (12800 + L_pc - .) / 4 , 4, 0xbf810000
.section .rodata,"a"
.p2align 6
.amdhsa_kernel standalone__gqa_softmax__decode_kernel
  .amdhsa_next_free_vgpr 128
  .amdhsa_next_free_sgpr 64
  .amdhsa_accum_offset 128
  .amdhsa_group_segment_fixed_size 0
  .amdhsa_kernarg_size 48
  .amdhsa_user_sgpr_count 2
  .amdhsa_user_sgpr_kernarg_segment_ptr 1
  .amdhsa_system_sgpr_workgroup_id_x 1
  .amdhsa_float_denorm_mode_32 3
.end_amdhsa_kernel
```
